```python
import torch

def _softmax(x, axis=-1):
    return torch.softmax(x, dim=axis)
def _gelu(x):
    return torch.nn.functional.gelu(x, approximate="tanh")
def _silu(x):
    return torch.nn.functional.silu(x)
def _sigmoid(x):
    return torch.sigmoid(x)
def _layernorm(x, axis=-1, eps=1e-5):
    m = x.mean(dim=axis, keepdim=True)
    v = x.var(dim=axis, keepdim=True, unbiased=False)
    return (x - m) / torch.sqrt(v + eps)
def _scatter_add(tgt, idx, src, axis=0):
    return tgt.clone().index_add_(axis, idx, src)
def _segment_sum(src, seg, n):
    out = torch.zeros((n,) + src.shape[1:], dtype=src.dtype)
    return out.index_add_(0, seg, src)
def _pad(x, pw):
    flat = tuple(v for pair in reversed(pw) for v in pair)
    return torch.nn.functional.pad(x, flat)

kernel_name = 'parallel_sum__gqa_block_cached__dense_activation_gelu__decode'

def setup_inputs():

    _w = (lambda a: (lambda t: t.to(torch.bfloat16) if t.is_floating_point() else t)(torch.as_tensor(a)))
    def _A_setup():
        B, Sq, D = 1, 1, 512
        Hq, Hkv, Sk, Dh = 32, 8, 65536, 128
        assert Hq % Hkv == 0, (Hq, Hkv)
        return {
            "x": _w((lambda *s: torch.randn(*s, dtype=torch.bfloat16) * 0.05)(B, Sq, D)),
            "k_cache": _w((lambda *s: torch.randn(*s, dtype=torch.bfloat16) * 3.2)(B, Hkv, Sk, Dh)),
            "v_cache": _w((lambda *s: torch.randn(*s, dtype=torch.bfloat16) * 0.8)(B, Hkv, Sk, Dh)),
            "wq": _w((lambda *s: torch.randn(*s, dtype=torch.bfloat16) * 3.2)(D, Hq * Dh) * (D ** -0.5)),
            "wo": _w((lambda *s: torch.randn(*s, dtype=torch.bfloat16) * 0.8)(Hq * Dh, D) * ((Hq * Dh) ** -0.5)),
        }
    _A_in = _A_setup()

    def _B_setup():
        B, S, D, F = 1, 1, 512, 1792
        return {
            "x": _w((lambda *s: torch.randn(*s, dtype=torch.bfloat16) * 0.05)(B, S, D)),
            "w1": _w((lambda *s: torch.randn(*s, dtype=torch.bfloat16) * 3.2)(D, F) * (D ** -0.5)),
            "b1": _w((lambda *s: torch.randn(*s, dtype=torch.bfloat16) * 3.2)(F) * 0.01),
            "w2": _w((lambda *s: torch.randn(*s, dtype=torch.bfloat16) * 0.4)(F, D) * (F ** -0.5)),
            "b2": _w((lambda *s: torch.randn(*s, dtype=torch.bfloat16) * 0.4)(D) * 0.01),
        }
    _B_in = _B_setup()

    return {
        "A_x": _A_in["x"],
        "A_k_cache": _A_in["k_cache"],
        "A_v_cache": _A_in["v_cache"],
        "A_wq": _A_in["wq"],
        "A_wo": _A_in["wo"],
        "B_x": _B_in["x"],
        "B_w1": _B_in["w1"],
        "B_b1": _B_in["b1"],
        "B_w2": _B_in["w2"],
        "B_b2": _B_in["b2"],
    }

def reference(A_x, A_k_cache, A_v_cache, A_wq, A_wo, B_x, B_w1, B_b1, B_w2, B_b2):
    def _A_ref(x, k_cache, v_cache, wq, wo):
        B, Sq, D = x.shape
        Hq, Dh = 32, 128
        Hkv = k_cache.shape[1]
        rep = Hq // Hkv
        q = (lambda x, *d: x.permute(*d))((x @ wq).reshape(B, Sq, Hq, Dh), 0, 2, 1, 3)
        k = (lambda x, n, axis: torch.repeat_interleave(x, n, dim=axis))(k_cache, rep, axis=1)
        v = (lambda x, n, axis: torch.repeat_interleave(x, n, dim=axis))(v_cache, rep, axis=1)
        scores = torch.einsum("bhqd,bhkd->bhqk", q, k) * (Dh ** -0.5)
        p = _softmax(scores, axis=-1)
        o = torch.einsum("bhqk,bhkd->bhqd", p, v)
        return (lambda x, *d: x.permute(*d))(o, 0, 2, 1, 3).reshape(B, Sq, Hq * Dh) @ wo

    def _B_ref(x, w1, b1, w2, b2):
        h = torch.einsum("bsd,df->bsf", x, w1) + b1
        h = _gelu(h)
        return torch.einsum("bsf,fd->bsd", h, w2) + b2

    x = A_x
    xn = _layernorm(x, axis=-1)
    return x + _A_ref(xn, A_k_cache, A_v_cache, A_wq, A_wo) + _B_ref(xn, B_w1, B_b1, B_w2, B_b2)
```

```asm
; @launch grid=(256,1,1) block=(192,1,1) lds=149504
.amdgcn_target "amdgcn-amd-amdhsa--gfx950"
.text
.globl parallel_sum__gqa_block_cached__dense_activation_gelu__decode_kernel
.p2align 8
.type parallel_sum__gqa_block_cached__dense_activation_gelu__decode_kernel,@function
parallel_sum__gqa_block_cached__dense_activation_gelu__decode_kernel:
    s_cmp_ge_u32 s2, 256
    s_cbranch_scc1 L_end
    s_load_dwordx8 s[4:11], s[0:1], 0
    s_load_dwordx2 s[12:13], s[0:1], 32
    s_load_dwordx4 s[16:19], s[0:1], 48
    s_load_dwordx8 s[20:27], s[0:1], 64
    s_load_dwordx2 s[28:29], s[0:1], 96
    v_lshrrev_b32 v1, 6, v0
    v_and_b32 v0, 63, v0
    v_readfirstlane_b32 s3, v1
    s_and_b32 s30, s2, 7
    s_lshr_b32 s31, s2, 3
    s_mov_b32 s33, 0x40000
    v_and_b32 v1, 15, v0
    v_lshrrev_b32 v2, 4, v0
    s_sub_u32 s15, s2, 64
    s_cmp_lt_u32 s15, 28
    s_cselect_b32 s32, 8, 0
    s_cmp_lt_u32 s31, 8
    s_cselect_b32 s32, 4, s32
    s_and_b32 s34, s2, 0xe4
    s_cmp_eq_u32 s34, 0xe4
    s_cselect_b32 s14, 32, 33
    s_lshr_b32 s34, s32, 1
    s_sub_u32 s14, s14, s34
    s_cmp_eq_u32 s3, 1
    s_cbranch_scc1 L_attn
    s_cmp_eq_u32 s3, 2
    s_cbranch_scc1 L_proj
    v_lshlrev_b32 v15, 2, v0
    v_add_u32 v15, 1024, v15
    v_mov_b32 v16, 1280
    v_mov_b32 v17, -16
    ds_write_b32 v15, v17
    v_add_u32 v18, 0, v2
    v_xor_b32 v18, v18, v1
    v_lshlrev_b32 v18, 4, v18
    v_lshl_add_u32 v4, v2, 8, v18
    v_add_u32 v18, 4, v2
    v_xor_b32 v18, v18, v1
    v_lshlrev_b32 v18, 4, v18
    v_lshl_add_u32 v5, v2, 8, v18
    v_add_u32 v18, 8, v2
    v_xor_b32 v18, v18, v1
    v_lshlrev_b32 v18, 4, v18
    v_lshl_add_u32 v6, v2, 8, v18
    v_add_u32 v18, 12, v2
    v_xor_b32 v18, v18, v1
    v_lshlrev_b32 v18, 4, v18
    v_lshl_add_u32 v7, v2, 8, v18
    v_add_u32 v18, 0, v2
    v_lshlrev_b32 v18, 1, v18
    v_xor_b32 v18, v18, v1
    v_lshlrev_b32 v18, 4, v18
    v_lshl_add_u32 v8, v2, 8, v18
    v_add_u32 v18, 4, v2
    v_lshlrev_b32 v18, 1, v18
    v_xor_b32 v18, v18, v1
    v_lshlrev_b32 v18, 4, v18
    v_lshl_add_u32 v9, v2, 8, v18
    s_mov_b32 s59, 3584
    s_cmp_eq_u32 s32, 4
    s_cselect_b32 s59, 8192, s59
    v_lshlrev_b32 v18, 1, v2
    v_and_b32 v14, 7, v0
    v_xor_b32 v18, v18, v14
    v_lshlrev_b32 v18, 4, v18
    v_lshrrev_b32 v14, 3, v0
    v_mad_u32_u24 v10, v14, s59, v18
    s_lshl_b32 s34, s59, 3
    s_sub_u32 s34, s34, 1024
    v_add_u32 v11, s34, v10
    v_add_u32 v12, s34, v11
    v_add_u32 v13, s34, v12
    s_lshl_b32 s59, s59, 5
    v_lshlrev_b32 v14, 4, v0
    s_mov_b32 s40, 0x200
    s_mov_b32 s41, -1
    s_lshr_b32 s38, s32, 1
    s_lshl_b32 s34, s31, 5
    s_add_u32 s52, s34, s38
    s_lshl_b32 s52, s52, 14
    s_lshl_b32 s34, s30, 24
    s_mov_b32 s54, 2048
    s_mov_b32 s55, -8
    s_mov_b32 s56, 0
    s_mov_b32 s57, 0
    s_add_u32 s58, s38, s14
    s_waitcnt lgkmcnt(0)
    s_add_u32 s44, s6, s34
    s_addc_u32 s45, s7, 0
    s_mov_b32 s46, 16777216
    s_mov_b32 s47, 0x00020000
    s_add_u32 s48, s8, s34
    s_addc_u32 s49, s9, 0
    s_mov_b32 s50, 16777216
    s_mov_b32 s51, 0x00020000
    v_mov_b32 v20, 0
    s_mov_b32 s36, -1
    s_mov_b32 s37, -1
    s_cmp_lg_u32 s32, 0
    s_cbranch_scc1 L_pre
    v_mov_b32 v20, -4
    s_mov_b32 s36, 9
    s_mov_b32 s37, 11
    s_mov_b32 s38, 1
    s_add_u32 s53, s52, 0
    s_waitcnt vmcnt(19)
    buffer_load_dwordx4 a[0:3], v4, s[44:47], s53 offen offset:0 nt
    s_waitcnt vmcnt(19)
    buffer_load_dwordx4 a[4:7], v5, s[44:47], s53 offen offset:1024 nt
    s_waitcnt vmcnt(19)
    buffer_load_dwordx4 a[8:11], v6, s[44:47], s53 offen offset:2048 nt
    s_waitcnt vmcnt(19)
    buffer_load_dwordx4 a[12:15], v7, s[44:47], s53 offen offset:3072 nt
    v_add_u32 v17, -2, v20
    ds_write_b32 v15, v17
    s_add_u32 s53, s52, 4096
    s_waitcnt vmcnt(19)
    buffer_load_dwordx4 a[16:19], v4, s[44:47], s53 offen offset:0 nt
    s_waitcnt vmcnt(19)
    buffer_load_dwordx4 a[20:23], v5, s[44:47], s53 offen offset:1024 nt
    s_waitcnt vmcnt(19)
    buffer_load_dwordx4 a[24:27], v6, s[44:47], s53 offen offset:2048 nt
    s_waitcnt vmcnt(19)
    buffer_load_dwordx4 a[28:31], v7, s[44:47], s53 offen offset:3072 nt
    s_add_u32 s53, s52, 8192
    s_waitcnt vmcnt(19)
    buffer_load_dwordx4 a[32:35], v4, s[44:47], s53 offen offset:0 nt
    s_waitcnt vmcnt(19)
    buffer_load_dwordx4 a[36:39], v5, s[44:47], s53 offen offset:1024 nt
    s_waitcnt vmcnt(19)
    buffer_load_dwordx4 a[40:43], v6, s[44:47], s53 offen offset:2048 nt
    s_waitcnt vmcnt(19)
    buffer_load_dwordx4 a[44:47], v7, s[44:47], s53 offen offset:3072 nt
    v_add_u32 v17, -1, v20
    ds_write_b32 v15, v17
    s_add_u32 s53, s52, 12288
    s_waitcnt vmcnt(19)
    buffer_load_dwordx4 a[48:51], v4, s[44:47], s53 offen offset:0 nt
    s_waitcnt vmcnt(19)
    buffer_load_dwordx4 a[52:55], v5, s[44:47], s53 offen offset:1024 nt
    s_waitcnt vmcnt(19)
    buffer_load_dwordx4 a[56:59], v6, s[44:47], s53 offen offset:2048 nt
    s_waitcnt vmcnt(19)
    buffer_load_dwordx4 a[60:63], v7, s[44:47], s53 offen offset:3072 nt
    v_add_u32 v20, 2, v20
    s_barrier
    s_add_u32 s53, s52, 0
    s_waitcnt vmcnt(19)
    buffer_load_dwordx4 a[64:67], v8, s[48:51], s53 offen offset:0 nt
    s_waitcnt vmcnt(19)
    buffer_load_dwordx4 a[68:71], v9, s[48:51], s53 offen offset:1024 nt
    s_waitcnt vmcnt(19)
    buffer_load_dwordx4 a[72:75], v8, s[48:51], s53 offen offset:2048 nt
    s_waitcnt vmcnt(19)
    buffer_load_dwordx4 a[76:79], v9, s[48:51], s53 offen offset:3072 nt
    v_add_u32 v17, -2, v20
    ds_write_b32 v15, v17
    s_add_u32 s53, s52, 4096
    s_waitcnt vmcnt(19)
    buffer_load_dwordx4 a[80:83], v8, s[48:51], s53 offen offset:0 nt
    s_waitcnt vmcnt(19)
    buffer_load_dwordx4 a[84:87], v9, s[48:51], s53 offen offset:1024 nt
    s_waitcnt vmcnt(19)
    buffer_load_dwordx4 a[88:91], v8, s[48:51], s53 offen offset:2048 nt
    s_waitcnt vmcnt(19)
    buffer_load_dwordx4 a[92:95], v9, s[48:51], s53 offen offset:3072 nt
    s_add_u32 s53, s52, 8192
    s_waitcnt vmcnt(19)
    buffer_load_dwordx4 a[96:99], v8, s[48:51], s53 offen offset:0 nt
    s_waitcnt vmcnt(19)
    buffer_load_dwordx4 a[100:103], v9, s[48:51], s53 offen offset:1024 nt
    s_waitcnt vmcnt(19)
    buffer_load_dwordx4 a[104:107], v8, s[48:51], s53 offen offset:2048 nt
    s_waitcnt vmcnt(19)
    buffer_load_dwordx4 a[108:111], v9, s[48:51], s53 offen offset:3072 nt
    v_add_u32 v17, -1, v20
    ds_write_b32 v15, v17
    s_add_u32 s53, s52, 12288
    s_waitcnt vmcnt(19)
    buffer_load_dwordx4 a[112:115], v8, s[48:51], s53 offen offset:0 nt
    s_waitcnt vmcnt(19)
    buffer_load_dwordx4 a[116:119], v9, s[48:51], s53 offen offset:1024 nt
    s_waitcnt vmcnt(19)
    buffer_load_dwordx4 a[120:123], v8, s[48:51], s53 offen offset:2048 nt
    s_waitcnt vmcnt(19)
    buffer_load_dwordx4 a[124:127], v9, s[48:51], s53 offen offset:3072 nt
    v_add_u32 v20, 2, v20
    s_add_u32 s52, s52, 16384
    s_branch L_ldk
L_sp0:
    v_add_u32 v10, s54, v14
    s_add_u32 s54, s54, 16384
    s_cmp_eq_u32 s54, 149504
    s_cselect_b32 s54, 2048, s54
    s_add_u32 s55, s55, 1
    v_add_u32 v11, s54, v14
    s_add_u32 s54, s54, 16384
    s_cmp_eq_u32 s54, 149504
    s_cselect_b32 s54, 2048, s54
    s_add_u32 s55, s55, 1
    s_cmp_lt_i32 s56, s55
    s_cbranch_scc1 L_slow1
L_back2:
    s_add_u32 m0, s54, 0
    s_add_u32 s53, s52, 0
    s_waitcnt vmcnt(19)
    buffer_load_dwordx4 v4, s[44:47], s53 offen offset:0 nt lds
    ds_write_b128 v10, a[0:3] offset:0
    ds_write_b128 v11, a[64:67] offset:0
    s_waitcnt vmcnt(19)
    buffer_load_dwordx4 v5, s[44:47], s53 offen offset:1024 nt lds
    ds_write_b128 v10, a[4:7] offset:1024
    ds_write_b128 v11, a[68:71] offset:1024
    s_waitcnt vmcnt(19)
    buffer_load_dwordx4 v6, s[44:47], s53 offen offset:2048 nt lds
    ds_write_b128 v10, a[8:11] offset:2048
    ds_write_b128 v11, a[72:75] offset:2048
    s_waitcnt vmcnt(19)
    buffer_load_dwordx4 v7, s[44:47], s53 offen offset:3072 nt lds
    v_add_u32 v17, -2, v20
    ds_write_b32 v15, v17
    ds_write_b128 v10, a[12:15] offset:3072
    ds_write_b128 v11, a[76:79] offset:3072
    s_add_u32 m0, s54, 4096
    s_add_u32 s53, s52, 4096
    s_waitcnt vmcnt(19)
    buffer_load_dwordx4 v4, s[44:47], s53 offen offset:0 nt lds
    ds_write_b128 v10, a[16:19] offset:4096
    ds_write_b128 v11, a[80:83] offset:4096
    s_waitcnt vmcnt(19)
    buffer_load_dwordx4 v5, s[44:47], s53 offen offset:1024 nt lds
    ds_write_b128 v10, a[20:23] offset:5120
    ds_write_b128 v11, a[84:87] offset:5120
    s_waitcnt vmcnt(19)
    buffer_load_dwordx4 v6, s[44:47], s53 offen offset:2048 nt lds
    ds_write_b128 v10, a[24:27] offset:6144
    ds_write_b128 v11, a[88:91] offset:6144
    s_waitcnt vmcnt(19)
    buffer_load_dwordx4 v7, s[44:47], s53 offen offset:3072 nt lds
    ds_write_b128 v10, a[28:31] offset:7168
    ds_write_b128 v11, a[92:95] offset:7168
    s_add_u32 m0, s54, 8192
    s_add_u32 s53, s52, 8192
    s_waitcnt vmcnt(19)
    buffer_load_dwordx4 v4, s[44:47], s53 offen offset:0 nt lds
    ds_write_b128 v10, a[32:35] offset:8192
    ds_write_b128 v11, a[96:99] offset:8192
    s_waitcnt vmcnt(19)
    buffer_load_dwordx4 v5, s[44:47], s53 offen offset:1024 nt lds
    ds_write_b128 v10, a[36:39] offset:9216
    ds_write_b128 v11, a[100:103] offset:9216
    s_waitcnt vmcnt(19)
    buffer_load_dwordx4 v6, s[44:47], s53 offen offset:2048 nt lds
    ds_write_b128 v10, a[40:43] offset:10240
    ds_write_b128 v11, a[104:107] offset:10240
    ds_read_b32 v18, v16
    s_waitcnt vmcnt(19)
    buffer_load_dwordx4 v7, s[44:47], s53 offen offset:3072 nt lds
    v_add_u32 v17, -1, v20
    ds_write_b32 v15, v17
    ds_write_b128 v10, a[44:47] offset:11264
    ds_write_b128 v11, a[108:111] offset:11264
    s_add_u32 m0, s54, 12288
    s_add_u32 s53, s52, 12288
    s_waitcnt vmcnt(19)
    buffer_load_dwordx4 v4, s[44:47], s53 offen offset:0 nt lds
    ds_write_b128 v10, a[48:51] offset:12288
    ds_write_b128 v11, a[112:115] offset:12288
    s_waitcnt vmcnt(19)
    buffer_load_dwordx4 v5, s[44:47], s53 offen offset:1024 nt lds
    ds_write_b128 v10, a[52:55] offset:13312
    ds_write_b128 v11, a[116:119] offset:13312
    s_waitcnt lgkmcnt(0)
    v_readfirstlane_b32 s56, v18
    s_add_u32 s54, s54, 16384
    s_cmp_eq_u32 s54, 149504
    s_cselect_b32 s54, 2048, s54
    s_add_u32 s55, s55, 1
    s_waitcnt vmcnt(19)
    buffer_load_dwordx4 v6, s[44:47], s53 offen offset:2048 nt lds
    ds_write_b128 v10, a[56:59] offset:14336
    ds_write_b128 v11, a[120:123] offset:14336
    s_waitcnt vmcnt(19)
    buffer_load_dwordx4 v7, s[44:47], s53 offen offset:3072 nt lds
    ds_write_b128 v10, a[60:63] offset:15360
    ds_write_b128 v11, a[124:127] offset:15360
    v_add_u32 v20, 6, v20
    s_branch L_ldv
L_pre:
    s_add_u32 s34, s2, 1
    s_and_b32 s34, s34, 7
    s_lshl_b32 s34, s34, 10
    s_lshl_b32 s35, s31, 7
    s_add_u32 s34, s34, s35
    s_sub_u32 s35, 4194304, s34
    s_add_u32 s60, s10, s34
    s_addc_u32 s61, s11, 0
    s_mov_b32 s62, s35
    s_mov_b32 s63, 0x00020000
    s_cmp_eq_u32 s32, 4
    s_cbranch_scc1 L_pre0
    s_lshl_b32 s34, s15, 7
    s_sub_u32 s35, 1835008, s34
    s_add_u32 s60, s16, s34
    s_addc_u32 s61, s17, 0
    s_mov_b32 s62, s35
    s_mov_b32 s63, 0x00020000
L_pre0:
    s_mov_b32 s53, 0
    s_barrier
L_pre1:
    s_add_u32 m0, s54, 0
    s_waitcnt vmcnt(19)
    buffer_load_dwordx4 v10, s[60:63], s53 offen offset:0 nt lds
    s_waitcnt vmcnt(19)
    buffer_load_dwordx4 v11, s[60:63], s53 offen offset:1024 nt lds
    s_waitcnt vmcnt(19)
    buffer_load_dwordx4 v12, s[60:63], s53 offen offset:2048 nt lds
    s_waitcnt vmcnt(19)
    buffer_load_dwordx4 v13, s[60:63], s53 offen offset:3072 nt lds
    v_add_u32 v17, -2, v20
    ds_write_b32 v15, v17
    s_add_u32 s53, s53, s59
    s_add_u32 m0, s54, 4096
    s_waitcnt vmcnt(19)
    buffer_load_dwordx4 v10, s[60:63], s53 offen offset:0 nt lds
    s_waitcnt vmcnt(19)
    buffer_load_dwordx4 v11, s[60:63], s53 offen offset:1024 nt lds
    s_waitcnt vmcnt(19)
    buffer_load_dwordx4 v12, s[60:63], s53 offen offset:2048 nt lds
    s_waitcnt vmcnt(19)
    buffer_load_dwordx4 v13, s[60:63], s53 offen offset:3072 nt lds
    s_add_u32 s53, s53, s59
    s_add_u32 m0, s54, 8192
    s_waitcnt vmcnt(19)
    buffer_load_dwordx4 v10, s[60:63], s53 offen offset:0 nt lds
    s_waitcnt vmcnt(19)
    buffer_load_dwordx4 v11, s[60:63], s53 offen offset:1024 nt lds
    s_waitcnt vmcnt(19)
    buffer_load_dwordx4 v12, s[60:63], s53 offen offset:2048 nt lds
    s_waitcnt vmcnt(19)
    buffer_load_dwordx4 v13, s[60:63], s53 offen offset:3072 nt lds
    v_add_u32 v17, -1, v20
    ds_write_b32 v15, v17
    s_add_u32 s53, s53, s59
    s_add_u32 m0, s54, 12288
    s_waitcnt vmcnt(19)
    buffer_load_dwordx4 v10, s[60:63], s53 offen offset:0 nt lds
    s_waitcnt vmcnt(19)
    buffer_load_dwordx4 v11, s[60:63], s53 offen offset:1024 nt lds
    s_add_u32 s54, s54, 16384
    s_cmp_eq_u32 s54, 149504
    s_cselect_b32 s54, 2048, s54
    s_add_u32 s55, s55, 1
    s_waitcnt vmcnt(19)
    buffer_load_dwordx4 v12, s[60:63], s53 offen offset:2048 nt lds
    s_waitcnt vmcnt(19)
    buffer_load_dwordx4 v13, s[60:63], s53 offen offset:3072 nt lds
    s_add_u32 s53, s53, s59
    v_add_u32 v20, 2, v20
    s_add_u32 s57, s57, 1
    s_cmp_lt_u32 s57, 4
    s_cbranch_scc1 L_pre1
    s_cmp_eq_u32 s32, 4
    s_cbranch_scc1 L_ldk
L_prew:
    s_lshl_b32 s34, s15, 16
    s_add_u32 s60, s20, s34
    s_addc_u32 s61, s21, 0
    s_mov_b32 s62, 65536
    s_mov_b32 s63, 0x00020000
    s_mov_b32 s53, 0
L_pre2:
    s_add_u32 m0, s54, 0
    s_waitcnt vmcnt(19)
    buffer_load_dwordx4 v14, s[60:63], s53 offen offset:0 nt lds
    s_waitcnt vmcnt(19)
    buffer_load_dwordx4 v14, s[60:63], s53 offen offset:1024 nt lds
    s_waitcnt vmcnt(19)
    buffer_load_dwordx4 v14, s[60:63], s53 offen offset:2048 nt lds
    s_waitcnt vmcnt(19)
    buffer_load_dwordx4 v14, s[60:63], s53 offen offset:3072 nt lds
    v_add_u32 v17, -2, v20
    ds_write_b32 v15, v17
    s_add_u32 s53, s53, 4096
    s_add_u32 m0, s54, 4096
    s_waitcnt vmcnt(19)
    buffer_load_dwordx4 v14, s[60:63], s53 offen offset:0 nt lds
    s_waitcnt vmcnt(19)
    buffer_load_dwordx4 v14, s[60:63], s53 offen offset:1024 nt lds
    s_waitcnt vmcnt(19)
    buffer_load_dwordx4 v14, s[60:63], s53 offen offset:2048 nt lds
    s_waitcnt vmcnt(19)
    buffer_load_dwordx4 v14, s[60:63], s53 offen offset:3072 nt lds
    s_add_u32 s53, s53, 4096
    s_add_u32 m0, s54, 8192
    s_waitcnt vmcnt(19)
    buffer_load_dwordx4 v14, s[60:63], s53 offen offset:0 nt lds
    s_waitcnt vmcnt(19)
    buffer_load_dwordx4 v14, s[60:63], s53 offen offset:1024 nt lds
    s_waitcnt vmcnt(19)
    buffer_load_dwordx4 v14, s[60:63], s53 offen offset:2048 nt lds
    s_waitcnt vmcnt(19)
    buffer_load_dwordx4 v14, s[60:63], s53 offen offset:3072 nt lds
    v_add_u32 v17, -1, v20
    ds_write_b32 v15, v17
    s_add_u32 s53, s53, 4096
    s_add_u32 m0, s54, 12288
    s_waitcnt vmcnt(19)
    buffer_load_dwordx4 v14, s[60:63], s53 offen offset:0 nt lds
    s_waitcnt vmcnt(19)
    buffer_load_dwordx4 v14, s[60:63], s53 offen offset:1024 nt lds
    s_add_u32 s54, s54, 16384
    s_cmp_eq_u32 s54, 149504
    s_cselect_b32 s54, 2048, s54
    s_add_u32 s55, s55, 1
    s_waitcnt vmcnt(19)
    buffer_load_dwordx4 v14, s[60:63], s53 offen offset:2048 nt lds
    s_waitcnt vmcnt(19)
    buffer_load_dwordx4 v14, s[60:63], s53 offen offset:3072 nt lds
    s_add_u32 s53, s53, 4096
    v_add_u32 v20, 2, v20
    s_add_u32 s57, s57, 1
    s_cmp_lt_u32 s57, 8
    s_cbranch_scc1 L_pre2
L_ldk:
    s_cmp_lt_i32 s56, s55
    s_cbranch_scc1 L_slow3
L_back4:
    s_add_u32 m0, s54, 0
    s_add_u32 s53, s52, 0
    s_waitcnt vmcnt(19)
    buffer_load_dwordx4 v4, s[44:47], s53 offen offset:0 nt lds
    s_waitcnt vmcnt(19)
    buffer_load_dwordx4 v5, s[44:47], s53 offen offset:1024 nt lds
    s_waitcnt vmcnt(19)
    buffer_load_dwordx4 v6, s[44:47], s53 offen offset:2048 nt lds
    s_waitcnt vmcnt(19)
    buffer_load_dwordx4 v7, s[44:47], s53 offen offset:3072 nt lds
    v_add_u32 v17, -2, v20
    ds_write_b32 v15, v17
    s_add_u32 m0, s54, 4096
    s_add_u32 s53, s52, 4096
    s_waitcnt vmcnt(19)
    buffer_load_dwordx4 v4, s[44:47], s53 offen offset:0 nt lds
    s_waitcnt vmcnt(19)
    buffer_load_dwordx4 v5, s[44:47], s53 offen offset:1024 nt lds
    s_waitcnt vmcnt(19)
    buffer_load_dwordx4 v6, s[44:47], s53 offen offset:2048 nt lds
    s_waitcnt vmcnt(19)
    buffer_load_dwordx4 v7, s[44:47], s53 offen offset:3072 nt lds
    s_add_u32 m0, s54, 8192
    s_add_u32 s53, s52, 8192
    s_waitcnt vmcnt(19)
    buffer_load_dwordx4 v4, s[44:47], s53 offen offset:0 nt lds
    s_waitcnt vmcnt(19)
    buffer_load_dwordx4 v5, s[44:47], s53 offen offset:1024 nt lds
    s_waitcnt vmcnt(19)
    buffer_load_dwordx4 v6, s[44:47], s53 offen offset:2048 nt lds
    ds_read_b32 v18, v16
    s_waitcnt vmcnt(19)
    buffer_load_dwordx4 v7, s[44:47], s53 offen offset:3072 nt lds
    v_add_u32 v17, -1, v20
    ds_write_b32 v15, v17
    s_add_u32 m0, s54, 12288
    s_add_u32 s53, s52, 12288
    s_waitcnt vmcnt(19)
    buffer_load_dwordx4 v4, s[44:47], s53 offen offset:0 nt lds
    s_waitcnt vmcnt(19)
    buffer_load_dwordx4 v5, s[44:47], s53 offen offset:1024 nt lds
    s_waitcnt lgkmcnt(0)
    v_readfirstlane_b32 s56, v18
    s_add_u32 s54, s54, 16384
    s_cmp_eq_u32 s54, 149504
    s_cselect_b32 s54, 2048, s54
    s_add_u32 s55, s55, 1
    s_waitcnt vmcnt(19)
    buffer_load_dwordx4 v6, s[44:47], s53 offen offset:2048 nt lds
    s_waitcnt vmcnt(19)
    buffer_load_dwordx4 v7, s[44:47], s53 offen offset:3072 nt lds
    v_add_u32 v20, 2, v20
L_ldv:
    s_cmp_lt_i32 s56, s55
    s_cbranch_scc1 L_slow5
L_back6:
    s_add_u32 m0, s54, 0
    s_add_u32 s53, s52, 0
    s_waitcnt vmcnt(19)
    buffer_load_dwordx4 v8, s[48:51], s53 offen offset:0 nt lds
    s_waitcnt vmcnt(19)
    buffer_load_dwordx4 v9, s[48:51], s53 offen offset:1024 nt lds
    s_waitcnt vmcnt(19)
    buffer_load_dwordx4 v8, s[48:51], s53 offen offset:2048 nt lds
    s_waitcnt vmcnt(19)
    buffer_load_dwordx4 v9, s[48:51], s53 offen offset:3072 nt lds
    v_add_u32 v17, -2, v20
    ds_write_b32 v15, v17
    s_add_u32 m0, s54, 4096
    s_add_u32 s53, s52, 4096
    s_waitcnt vmcnt(19)
    buffer_load_dwordx4 v8, s[48:51], s53 offen offset:0 nt lds
    s_waitcnt vmcnt(19)
    buffer_load_dwordx4 v9, s[48:51], s53 offen offset:1024 nt lds
    s_waitcnt vmcnt(19)
    buffer_load_dwordx4 v8, s[48:51], s53 offen offset:2048 nt lds
    s_waitcnt vmcnt(19)
    buffer_load_dwordx4 v9, s[48:51], s53 offen offset:3072 nt lds
    s_add_u32 m0, s54, 8192
    s_add_u32 s53, s52, 8192
    s_waitcnt vmcnt(19)
    buffer_load_dwordx4 v8, s[48:51], s53 offen offset:0 nt lds
    s_waitcnt vmcnt(19)
    buffer_load_dwordx4 v9, s[48:51], s53 offen offset:1024 nt lds
    s_waitcnt vmcnt(19)
    buffer_load_dwordx4 v8, s[48:51], s53 offen offset:2048 nt lds
    ds_read2_b32 v[18:19], v16 offset1:64
    s_waitcnt vmcnt(19)
    buffer_load_dwordx4 v9, s[48:51], s53 offen offset:3072 nt lds
    v_add_u32 v17, -1, v20
    ds_write_b32 v15, v17
    s_add_u32 m0, s54, 12288
    s_add_u32 s53, s52, 12288
    s_waitcnt vmcnt(19)
    buffer_load_dwordx4 v8, s[48:51], s53 offen offset:0 nt lds
    s_waitcnt vmcnt(19)
    buffer_load_dwordx4 v9, s[48:51], s53 offen offset:1024 nt lds
    s_waitcnt lgkmcnt(0)
    v_readfirstlane_b32 s56, v18
    v_readfirstlane_b32 s39, v19
    s_add_u32 s54, s54, 16384
    s_cmp_eq_u32 s54, 149504
    s_cselect_b32 s54, 2048, s54
    s_add_u32 s55, s55, 1
    s_waitcnt vmcnt(19)
    buffer_load_dwordx4 v8, s[48:51], s53 offen offset:2048 nt lds
    s_add_u32 s52, s52, 16384
    s_add_u32 s38, s38, 1
    s_cmp_eq_u32 s39, 20
    s_cselect_b32 s34, s38, 32
    s_bitcmp1_b64 s[40:41], s34
    s_waitcnt vmcnt(19)
    buffer_load_dwordx4 v9, s[48:51], s53 offen offset:3072 nt lds
    v_add_u32 v20, 2, v20
    s_cbranch_scc0 L_ldk
L_rare:
    s_cmp_eq_u32 s38, s36
    s_cbranch_scc1 L_sp0
    s_cmp_lt_u32 s38, 32
    s_cbranch_scc1 L_disp
    s_lshr_b32 s34, s31, 1
    s_lshl_b32 s34, s34, 5
    s_and_b32 s35, s31, 1
    s_add_u32 s52, s34, s35
    s_lshr_b32 s34, s31, 2
    s_add_u32 s34, s34, 4
    s_lshl_b32 s34, s34, 5
    s_and_b32 s35, s31, 3
    s_add_u32 s34, s34, s35
    s_cmp_lt_u32 s31, 16
    s_cselect_b32 s52, s52, s34
    s_lshl_b32 s52, s52, 14
    s_cmp_lt_u32 s38, s58
    s_cbranch_scc1 L_disp
    s_add_u32 s34, s2, 0
    s_and_b32 s34, s34, 7
    s_lshl_b32 s34, s34, 19
    s_lshl_b32 s35, s31, 14
    s_add_u32 s34, s34, s35
    s_add_u32 s60, s12, s34
    s_addc_u32 s61, s13, 0
    s_mov_b32 s62, 16384
    s_mov_b32 s63, 0x00020000
    s_mov_b32 s53, 0
    s_cmp_lt_i32 s56, s55
    s_cbranch_scc1 L_slow7
L_back8:
    s_add_u32 m0, s54, 0
    s_waitcnt vmcnt(19)
    buffer_load_dwordx4 v14, s[60:63], s53 offen offset:0 nt lds
    s_waitcnt vmcnt(19)
    buffer_load_dwordx4 v14, s[60:63], s53 offen offset:1024 nt lds
    s_waitcnt vmcnt(19)
    buffer_load_dwordx4 v14, s[60:63], s53 offen offset:2048 nt lds
    s_waitcnt vmcnt(19)
    buffer_load_dwordx4 v14, s[60:63], s53 offen offset:3072 nt lds
    v_add_u32 v17, -2, v20
    ds_write_b32 v15, v17
    s_add_u32 s53, s53, 4096
    s_add_u32 m0, s54, 4096
    s_waitcnt vmcnt(19)
    buffer_load_dwordx4 v14, s[60:63], s53 offen offset:0 nt lds
    s_waitcnt vmcnt(19)
    buffer_load_dwordx4 v14, s[60:63], s53 offen offset:1024 nt lds
    s_waitcnt vmcnt(19)
    buffer_load_dwordx4 v14, s[60:63], s53 offen offset:2048 nt lds
    s_waitcnt vmcnt(19)
    buffer_load_dwordx4 v14, s[60:63], s53 offen offset:3072 nt lds
    s_add_u32 s53, s53, 4096
    s_add_u32 m0, s54, 8192
    s_waitcnt vmcnt(19)
    buffer_load_dwordx4 v14, s[60:63], s53 offen offset:0 nt lds
    s_waitcnt vmcnt(19)
    buffer_load_dwordx4 v14, s[60:63], s53 offen offset:1024 nt lds
    s_waitcnt vmcnt(19)
    buffer_load_dwordx4 v14, s[60:63], s53 offen offset:2048 nt lds
    ds_read_b32 v18, v16
    s_waitcnt vmcnt(19)
    buffer_load_dwordx4 v14, s[60:63], s53 offen offset:3072 nt lds
    v_add_u32 v17, -1, v20
    ds_write_b32 v15, v17
    s_add_u32 s53, s53, 4096
    s_add_u32 m0, s54, 12288
    s_waitcnt vmcnt(19)
    buffer_load_dwordx4 v14, s[60:63], s53 offen offset:0 nt lds
    s_waitcnt vmcnt(19)
    buffer_load_dwordx4 v14, s[60:63], s53 offen offset:1024 nt lds
    s_waitcnt lgkmcnt(0)
    v_readfirstlane_b32 s56, v18
    s_add_u32 s54, s54, 16384
    s_cmp_eq_u32 s54, 149504
    s_cselect_b32 s54, 2048, s54
    s_add_u32 s55, s55, 1
    s_waitcnt vmcnt(19)
    buffer_load_dwordx4 v14, s[60:63], s53 offen offset:2048 nt lds
    s_waitcnt vmcnt(19)
    buffer_load_dwordx4 v14, s[60:63], s53 offen offset:3072 nt lds
    s_add_u32 s53, s53, 4096
    v_add_u32 v20, 2, v20
    s_waitcnt vmcnt(16)
    v_add_u32 v17, -2, v20
    ds_write_b32 v15, v17
    s_waitcnt vmcnt(8)
    v_add_u32 v17, -1, v20
    ds_write_b32 v15, v17
    s_waitcnt vmcnt(0)
    v_add_u32 v17, 0, v20
    ds_write_b32 v15, v17
    s_waitcnt lgkmcnt(0)
    s_endpgm
L_disp:
    s_cmp_eq_u32 s39, 17
    s_cbranch_scc1 L_w17
    s_cmp_eq_u32 s39, 18
    s_cbranch_scc1 L_w18
    s_cmp_eq_u32 s39, 19
    s_cbranch_scc1 L_w19
    s_cmp_eq_u32 s39, 21
    s_cbranch_scc1 L_w21
    s_cmp_eq_u32 s39, 23
    s_cbranch_scc1 L_w23
    s_cmp_eq_u32 s39, 26
    s_cbranch_scc1 L_w26
    s_cmp_eq_u32 s39, 30
    s_cbranch_scc1 L_w30
    s_branch L_ldk
L_w17:
    s_cmp_lt_i32 s56, s55
    s_cbranch_scc1 L_slow9
L_back10:
    s_add_u32 m0, s54, 0
    s_add_u32 s53, s52, 0
    s_waitcnt vmcnt(16)
    buffer_load_dwordx4 v4, s[44:47], s53 offen offset:0 nt lds
    v_add_u32 v17, -2, v20
    ds_write_b32 v15, v17
    s_waitcnt vmcnt(16)
    buffer_load_dwordx4 v5, s[44:47], s53 offen offset:1024 nt lds
    s_waitcnt vmcnt(16)
    buffer_load_dwordx4 v6, s[44:47], s53 offen offset:2048 nt lds
    s_waitcnt vmcnt(16)
    buffer_load_dwordx4 v7, s[44:47], s53 offen offset:3072 nt lds
    s_add_u32 m0, s54, 4096
    s_add_u32 s53, s52, 4096
    s_waitcnt vmcnt(16)
    buffer_load_dwordx4 v4, s[44:47], s53 offen offset:0 nt lds
    s_waitcnt vmcnt(16)
    buffer_load_dwordx4 v5, s[44:47], s53 offen offset:1024 nt lds
    s_waitcnt vmcnt(16)
    buffer_load_dwordx4 v6, s[44:47], s53 offen offset:2048 nt lds
    s_waitcnt vmcnt(16)
    buffer_load_dwordx4 v7, s[44:47], s53 offen offset:3072 nt lds
    s_add_u32 m0, s54, 8192
    s_add_u32 s53, s52, 8192
    s_waitcnt vmcnt(16)
    buffer_load_dwordx4 v4, s[44:47], s53 offen offset:0 nt lds
    v_add_u32 v17, -1, v20
    ds_write_b32 v15, v17
    s_waitcnt vmcnt(16)
    buffer_load_dwordx4 v5, s[44:47], s53 offen offset:1024 nt lds
    s_waitcnt vmcnt(16)
    buffer_load_dwordx4 v6, s[44:47], s53 offen offset:2048 nt lds
    ds_read_b32 v18, v16
    s_waitcnt vmcnt(16)
    buffer_load_dwordx4 v7, s[44:47], s53 offen offset:3072 nt lds
    s_add_u32 m0, s54, 12288
    s_add_u32 s53, s52, 12288
    s_waitcnt vmcnt(16)
    buffer_load_dwordx4 v4, s[44:47], s53 offen offset:0 nt lds
    s_waitcnt vmcnt(16)
    buffer_load_dwordx4 v5, s[44:47], s53 offen offset:1024 nt lds
    s_waitcnt lgkmcnt(0)
    v_readfirstlane_b32 s56, v18
    s_add_u32 s54, s54, 16384
    s_cmp_eq_u32 s54, 149504
    s_cselect_b32 s54, 2048, s54
    s_add_u32 s55, s55, 1
    s_waitcnt vmcnt(16)
    buffer_load_dwordx4 v6, s[44:47], s53 offen offset:2048 nt lds
    s_waitcnt vmcnt(16)
    buffer_load_dwordx4 v7, s[44:47], s53 offen offset:3072 nt lds
    v_add_u32 v20, 2, v20
    s_cmp_lt_i32 s56, s55
    s_cbranch_scc1 L_slow11
L_back12:
    s_add_u32 m0, s54, 0
    s_add_u32 s53, s52, 0
    s_waitcnt vmcnt(16)
    buffer_load_dwordx4 v8, s[48:51], s53 offen offset:0 nt lds
    v_add_u32 v17, -2, v20
    ds_write_b32 v15, v17
    s_waitcnt vmcnt(16)
    buffer_load_dwordx4 v9, s[48:51], s53 offen offset:1024 nt lds
    s_waitcnt vmcnt(16)
    buffer_load_dwordx4 v8, s[48:51], s53 offen offset:2048 nt lds
    s_waitcnt vmcnt(16)
    buffer_load_dwordx4 v9, s[48:51], s53 offen offset:3072 nt lds
    s_add_u32 m0, s54, 4096
    s_add_u32 s53, s52, 4096
    s_waitcnt vmcnt(16)
    buffer_load_dwordx4 v8, s[48:51], s53 offen offset:0 nt lds
    s_waitcnt vmcnt(16)
    buffer_load_dwordx4 v9, s[48:51], s53 offen offset:1024 nt lds
    s_waitcnt vmcnt(16)
    buffer_load_dwordx4 v8, s[48:51], s53 offen offset:2048 nt lds
    s_waitcnt vmcnt(16)
    buffer_load_dwordx4 v9, s[48:51], s53 offen offset:3072 nt lds
    s_add_u32 m0, s54, 8192
    s_add_u32 s53, s52, 8192
    s_waitcnt vmcnt(16)
    buffer_load_dwordx4 v8, s[48:51], s53 offen offset:0 nt lds
    v_add_u32 v17, -1, v20
    ds_write_b32 v15, v17
    s_waitcnt vmcnt(16)
    buffer_load_dwordx4 v9, s[48:51], s53 offen offset:1024 nt lds
    s_waitcnt vmcnt(16)
    buffer_load_dwordx4 v8, s[48:51], s53 offen offset:2048 nt lds
    ds_read2_b32 v[18:19], v16 offset1:64
    s_waitcnt vmcnt(16)
    buffer_load_dwordx4 v9, s[48:51], s53 offen offset:3072 nt lds
    s_add_u32 m0, s54, 12288
    s_add_u32 s53, s52, 12288
    s_waitcnt vmcnt(16)
    buffer_load_dwordx4 v8, s[48:51], s53 offen offset:0 nt lds
    s_waitcnt vmcnt(16)
    buffer_load_dwordx4 v9, s[48:51], s53 offen offset:1024 nt lds
    s_waitcnt lgkmcnt(0)
    v_readfirstlane_b32 s56, v18
    v_readfirstlane_b32 s39, v19
    s_add_u32 s54, s54, 16384
    s_cmp_eq_u32 s54, 149504
    s_cselect_b32 s54, 2048, s54
    s_add_u32 s55, s55, 1
    s_waitcnt vmcnt(16)
    buffer_load_dwordx4 v8, s[48:51], s53 offen offset:2048 nt lds
    s_add_u32 s52, s52, 16384
    s_add_u32 s38, s38, 1
    s_cmp_eq_u32 s39, 17
    s_cselect_b32 s34, s38, 32
    s_bitcmp1_b64 s[40:41], s34
    s_waitcnt vmcnt(16)
    buffer_load_dwordx4 v9, s[48:51], s53 offen offset:3072 nt lds
    v_add_u32 v20, 2, v20
    s_cbranch_scc0 L_w17
    s_branch L_rare
L_w18:
    s_cmp_lt_i32 s56, s55
    s_cbranch_scc1 L_slow13
L_back14:
    s_add_u32 m0, s54, 0
    s_add_u32 s53, s52, 0
    s_waitcnt vmcnt(17)
    buffer_load_dwordx4 v4, s[44:47], s53 offen offset:0 nt lds
    s_waitcnt vmcnt(17)
    buffer_load_dwordx4 v5, s[44:47], s53 offen offset:1024 nt lds
    v_add_u32 v17, -2, v20
    ds_write_b32 v15, v17
    s_waitcnt vmcnt(17)
    buffer_load_dwordx4 v6, s[44:47], s53 offen offset:2048 nt lds
    s_waitcnt vmcnt(17)
    buffer_load_dwordx4 v7, s[44:47], s53 offen offset:3072 nt lds
    s_add_u32 m0, s54, 4096
    s_add_u32 s53, s52, 4096
    s_waitcnt vmcnt(17)
    buffer_load_dwordx4 v4, s[44:47], s53 offen offset:0 nt lds
    s_waitcnt vmcnt(17)
    buffer_load_dwordx4 v5, s[44:47], s53 offen offset:1024 nt lds
    s_waitcnt vmcnt(17)
    buffer_load_dwordx4 v6, s[44:47], s53 offen offset:2048 nt lds
    s_waitcnt vmcnt(17)
    buffer_load_dwordx4 v7, s[44:47], s53 offen offset:3072 nt lds
    s_add_u32 m0, s54, 8192
    s_add_u32 s53, s52, 8192
    s_waitcnt vmcnt(17)
    buffer_load_dwordx4 v4, s[44:47], s53 offen offset:0 nt lds
    s_waitcnt vmcnt(17)
    buffer_load_dwordx4 v5, s[44:47], s53 offen offset:1024 nt lds
    v_add_u32 v17, -1, v20
    ds_write_b32 v15, v17
    s_waitcnt vmcnt(17)
    buffer_load_dwordx4 v6, s[44:47], s53 offen offset:2048 nt lds
    ds_read_b32 v18, v16
    s_waitcnt vmcnt(17)
    buffer_load_dwordx4 v7, s[44:47], s53 offen offset:3072 nt lds
    s_add_u32 m0, s54, 12288
    s_add_u32 s53, s52, 12288
    s_waitcnt vmcnt(17)
    buffer_load_dwordx4 v4, s[44:47], s53 offen offset:0 nt lds
    s_waitcnt vmcnt(17)
    buffer_load_dwordx4 v5, s[44:47], s53 offen offset:1024 nt lds
    s_waitcnt lgkmcnt(0)
    v_readfirstlane_b32 s56, v18
    s_add_u32 s54, s54, 16384
    s_cmp_eq_u32 s54, 149504
    s_cselect_b32 s54, 2048, s54
    s_add_u32 s55, s55, 1
    s_waitcnt vmcnt(17)
    buffer_load_dwordx4 v6, s[44:47], s53 offen offset:2048 nt lds
    s_waitcnt vmcnt(17)
    buffer_load_dwordx4 v7, s[44:47], s53 offen offset:3072 nt lds
    v_add_u32 v20, 2, v20
    s_cmp_lt_i32 s56, s55
    s_cbranch_scc1 L_slow15
L_back16:
    s_add_u32 m0, s54, 0
    s_add_u32 s53, s52, 0
    s_waitcnt vmcnt(17)
    buffer_load_dwordx4 v8, s[48:51], s53 offen offset:0 nt lds
    s_waitcnt vmcnt(17)
    buffer_load_dwordx4 v9, s[48:51], s53 offen offset:1024 nt lds
    v_add_u32 v17, -2, v20
    ds_write_b32 v15, v17
    s_waitcnt vmcnt(17)
    buffer_load_dwordx4 v8, s[48:51], s53 offen offset:2048 nt lds
    s_waitcnt vmcnt(17)
    buffer_load_dwordx4 v9, s[48:51], s53 offen offset:3072 nt lds
    s_add_u32 m0, s54, 4096
    s_add_u32 s53, s52, 4096
    s_waitcnt vmcnt(17)
    buffer_load_dwordx4 v8, s[48:51], s53 offen offset:0 nt lds
    s_waitcnt vmcnt(17)
    buffer_load_dwordx4 v9, s[48:51], s53 offen offset:1024 nt lds
    s_waitcnt vmcnt(17)
    buffer_load_dwordx4 v8, s[48:51], s53 offen offset:2048 nt lds
    s_waitcnt vmcnt(17)
    buffer_load_dwordx4 v9, s[48:51], s53 offen offset:3072 nt lds
    s_add_u32 m0, s54, 8192
    s_add_u32 s53, s52, 8192
    s_waitcnt vmcnt(17)
    buffer_load_dwordx4 v8, s[48:51], s53 offen offset:0 nt lds
    s_waitcnt vmcnt(17)
    buffer_load_dwordx4 v9, s[48:51], s53 offen offset:1024 nt lds
    v_add_u32 v17, -1, v20
    ds_write_b32 v15, v17
    s_waitcnt vmcnt(17)
    buffer_load_dwordx4 v8, s[48:51], s53 offen offset:2048 nt lds
    ds_read2_b32 v[18:19], v16 offset1:64
    s_waitcnt vmcnt(17)
    buffer_load_dwordx4 v9, s[48:51], s53 offen offset:3072 nt lds
    s_add_u32 m0, s54, 12288
    s_add_u32 s53, s52, 12288
    s_waitcnt vmcnt(17)
    buffer_load_dwordx4 v8, s[48:51], s53 offen offset:0 nt lds
    s_waitcnt vmcnt(17)
    buffer_load_dwordx4 v9, s[48:51], s53 offen offset:1024 nt lds
    s_waitcnt lgkmcnt(0)
    v_readfirstlane_b32 s56, v18
    v_readfirstlane_b32 s39, v19
    s_add_u32 s54, s54, 16384
    s_cmp_eq_u32 s54, 149504
    s_cselect_b32 s54, 2048, s54
    s_add_u32 s55, s55, 1
    s_waitcnt vmcnt(17)
    buffer_load_dwordx4 v8, s[48:51], s53 offen offset:2048 nt lds
    s_add_u32 s52, s52, 16384
    s_add_u32 s38, s38, 1
    s_cmp_eq_u32 s39, 18
    s_cselect_b32 s34, s38, 32
    s_bitcmp1_b64 s[40:41], s34
    s_waitcnt vmcnt(17)
    buffer_load_dwordx4 v9, s[48:51], s53 offen offset:3072 nt lds
    v_add_u32 v20, 2, v20
    s_cbranch_scc0 L_w18
    s_branch L_rare
L_w19:
    s_cmp_lt_i32 s56, s55
    s_cbranch_scc1 L_slow17
L_back18:
    s_add_u32 m0, s54, 0
    s_add_u32 s53, s52, 0
    s_waitcnt vmcnt(18)
    buffer_load_dwordx4 v4, s[44:47], s53 offen offset:0 nt lds
    s_waitcnt vmcnt(18)
    buffer_load_dwordx4 v5, s[44:47], s53 offen offset:1024 nt lds
    s_waitcnt vmcnt(18)
    buffer_load_dwordx4 v6, s[44:47], s53 offen offset:2048 nt lds
    v_add_u32 v17, -2, v20
    ds_write_b32 v15, v17
    s_waitcnt vmcnt(18)
    buffer_load_dwordx4 v7, s[44:47], s53 offen offset:3072 nt lds
    s_add_u32 m0, s54, 4096
    s_add_u32 s53, s52, 4096
    s_waitcnt vmcnt(18)
    buffer_load_dwordx4 v4, s[44:47], s53 offen offset:0 nt lds
    s_waitcnt vmcnt(18)
    buffer_load_dwordx4 v5, s[44:47], s53 offen offset:1024 nt lds
    s_waitcnt vmcnt(18)
    buffer_load_dwordx4 v6, s[44:47], s53 offen offset:2048 nt lds
    s_waitcnt vmcnt(18)
    buffer_load_dwordx4 v7, s[44:47], s53 offen offset:3072 nt lds
    s_add_u32 m0, s54, 8192
    s_add_u32 s53, s52, 8192
    s_waitcnt vmcnt(18)
    buffer_load_dwordx4 v4, s[44:47], s53 offen offset:0 nt lds
    s_waitcnt vmcnt(18)
    buffer_load_dwordx4 v5, s[44:47], s53 offen offset:1024 nt lds
    s_waitcnt vmcnt(18)
    buffer_load_dwordx4 v6, s[44:47], s53 offen offset:2048 nt lds
    v_add_u32 v17, -1, v20
    ds_write_b32 v15, v17
    ds_read_b32 v18, v16
    s_waitcnt vmcnt(18)
    buffer_load_dwordx4 v7, s[44:47], s53 offen offset:3072 nt lds
    s_add_u32 m0, s54, 12288
    s_add_u32 s53, s52, 12288
    s_waitcnt vmcnt(18)
    buffer_load_dwordx4 v4, s[44:47], s53 offen offset:0 nt lds
    s_waitcnt vmcnt(18)
    buffer_load_dwordx4 v5, s[44:47], s53 offen offset:1024 nt lds
    s_waitcnt lgkmcnt(0)
    v_readfirstlane_b32 s56, v18
    s_add_u32 s54, s54, 16384
    s_cmp_eq_u32 s54, 149504
    s_cselect_b32 s54, 2048, s54
    s_add_u32 s55, s55, 1
    s_waitcnt vmcnt(18)
    buffer_load_dwordx4 v6, s[44:47], s53 offen offset:2048 nt lds
    s_waitcnt vmcnt(18)
    buffer_load_dwordx4 v7, s[44:47], s53 offen offset:3072 nt lds
    v_add_u32 v20, 2, v20
    s_cmp_lt_i32 s56, s55
    s_cbranch_scc1 L_slow19
L_back20:
    s_add_u32 m0, s54, 0
    s_add_u32 s53, s52, 0
    s_waitcnt vmcnt(18)
    buffer_load_dwordx4 v8, s[48:51], s53 offen offset:0 nt lds
    s_waitcnt vmcnt(18)
    buffer_load_dwordx4 v9, s[48:51], s53 offen offset:1024 nt lds
    s_waitcnt vmcnt(18)
    buffer_load_dwordx4 v8, s[48:51], s53 offen offset:2048 nt lds
    v_add_u32 v17, -2, v20
    ds_write_b32 v15, v17
    s_waitcnt vmcnt(18)
    buffer_load_dwordx4 v9, s[48:51], s53 offen offset:3072 nt lds
    s_add_u32 m0, s54, 4096
    s_add_u32 s53, s52, 4096
    s_waitcnt vmcnt(18)
    buffer_load_dwordx4 v8, s[48:51], s53 offen offset:0 nt lds
    s_waitcnt vmcnt(18)
    buffer_load_dwordx4 v9, s[48:51], s53 offen offset:1024 nt lds
    s_waitcnt vmcnt(18)
    buffer_load_dwordx4 v8, s[48:51], s53 offen offset:2048 nt lds
    s_waitcnt vmcnt(18)
    buffer_load_dwordx4 v9, s[48:51], s53 offen offset:3072 nt lds
    s_add_u32 m0, s54, 8192
    s_add_u32 s53, s52, 8192
    s_waitcnt vmcnt(18)
    buffer_load_dwordx4 v8, s[48:51], s53 offen offset:0 nt lds
    s_waitcnt vmcnt(18)
    buffer_load_dwordx4 v9, s[48:51], s53 offen offset:1024 nt lds
    s_waitcnt vmcnt(18)
    buffer_load_dwordx4 v8, s[48:51], s53 offen offset:2048 nt lds
    v_add_u32 v17, -1, v20
    ds_write_b32 v15, v17
    ds_read2_b32 v[18:19], v16 offset1:64
    s_waitcnt vmcnt(18)
    buffer_load_dwordx4 v9, s[48:51], s53 offen offset:3072 nt lds
    s_add_u32 m0, s54, 12288
    s_add_u32 s53, s52, 12288
    s_waitcnt vmcnt(18)
    buffer_load_dwordx4 v8, s[48:51], s53 offen offset:0 nt lds
    s_waitcnt vmcnt(18)
    buffer_load_dwordx4 v9, s[48:51], s53 offen offset:1024 nt lds
    s_waitcnt lgkmcnt(0)
    v_readfirstlane_b32 s56, v18
    v_readfirstlane_b32 s39, v19
    s_add_u32 s54, s54, 16384
    s_cmp_eq_u32 s54, 149504
    s_cselect_b32 s54, 2048, s54
    s_add_u32 s55, s55, 1
    s_waitcnt vmcnt(18)
    buffer_load_dwordx4 v8, s[48:51], s53 offen offset:2048 nt lds
    s_add_u32 s52, s52, 16384
    s_add_u32 s38, s38, 1
    s_cmp_eq_u32 s39, 19
    s_cselect_b32 s34, s38, 32
    s_bitcmp1_b64 s[40:41], s34
    s_waitcnt vmcnt(18)
    buffer_load_dwordx4 v9, s[48:51], s53 offen offset:3072 nt lds
    v_add_u32 v20, 2, v20
    s_cbranch_scc0 L_w19
    s_branch L_rare
L_w21:
    s_cmp_lt_i32 s56, s55
    s_cbranch_scc1 L_slow21
L_back22:
    s_add_u32 m0, s54, 0
    s_add_u32 s53, s52, 0
    s_waitcnt vmcnt(20)
    buffer_load_dwordx4 v4, s[44:47], s53 offen offset:0 nt lds
    s_waitcnt vmcnt(20)
    buffer_load_dwordx4 v5, s[44:47], s53 offen offset:1024 nt lds
    s_waitcnt vmcnt(20)
    buffer_load_dwordx4 v6, s[44:47], s53 offen offset:2048 nt lds
    s_waitcnt vmcnt(20)
    buffer_load_dwordx4 v7, s[44:47], s53 offen offset:3072 nt lds
    s_add_u32 m0, s54, 4096
    s_add_u32 s53, s52, 4096
    s_waitcnt vmcnt(20)
    buffer_load_dwordx4 v4, s[44:47], s53 offen offset:0 nt lds
    v_add_u32 v17, -2, v20
    ds_write_b32 v15, v17
    s_waitcnt vmcnt(20)
    buffer_load_dwordx4 v5, s[44:47], s53 offen offset:1024 nt lds
    s_waitcnt vmcnt(20)
    buffer_load_dwordx4 v6, s[44:47], s53 offen offset:2048 nt lds
    s_waitcnt vmcnt(20)
    buffer_load_dwordx4 v7, s[44:47], s53 offen offset:3072 nt lds
    s_add_u32 m0, s54, 8192
    s_add_u32 s53, s52, 8192
    s_waitcnt vmcnt(20)
    buffer_load_dwordx4 v4, s[44:47], s53 offen offset:0 nt lds
    s_waitcnt vmcnt(20)
    buffer_load_dwordx4 v5, s[44:47], s53 offen offset:1024 nt lds
    s_waitcnt vmcnt(20)
    buffer_load_dwordx4 v6, s[44:47], s53 offen offset:2048 nt lds
    ds_read_b32 v18, v16
    s_waitcnt vmcnt(20)
    buffer_load_dwordx4 v7, s[44:47], s53 offen offset:3072 nt lds
    s_add_u32 m0, s54, 12288
    s_add_u32 s53, s52, 12288
    s_waitcnt vmcnt(20)
    buffer_load_dwordx4 v4, s[44:47], s53 offen offset:0 nt lds
    v_add_u32 v17, -1, v20
    ds_write_b32 v15, v17
    s_waitcnt vmcnt(20)
    buffer_load_dwordx4 v5, s[44:47], s53 offen offset:1024 nt lds
    s_waitcnt lgkmcnt(0)
    v_readfirstlane_b32 s56, v18
    s_add_u32 s54, s54, 16384
    s_cmp_eq_u32 s54, 149504
    s_cselect_b32 s54, 2048, s54
    s_add_u32 s55, s55, 1
    s_waitcnt vmcnt(20)
    buffer_load_dwordx4 v6, s[44:47], s53 offen offset:2048 nt lds
    s_waitcnt vmcnt(20)
    buffer_load_dwordx4 v7, s[44:47], s53 offen offset:3072 nt lds
    v_add_u32 v20, 2, v20
    s_cmp_lt_i32 s56, s55
    s_cbranch_scc1 L_slow23
L_back24:
    s_add_u32 m0, s54, 0
    s_add_u32 s53, s52, 0
    s_waitcnt vmcnt(20)
    buffer_load_dwordx4 v8, s[48:51], s53 offen offset:0 nt lds
    s_waitcnt vmcnt(20)
    buffer_load_dwordx4 v9, s[48:51], s53 offen offset:1024 nt lds
    s_waitcnt vmcnt(20)
    buffer_load_dwordx4 v8, s[48:51], s53 offen offset:2048 nt lds
    s_waitcnt vmcnt(20)
    buffer_load_dwordx4 v9, s[48:51], s53 offen offset:3072 nt lds
    s_add_u32 m0, s54, 4096
    s_add_u32 s53, s52, 4096
    s_waitcnt vmcnt(20)
    buffer_load_dwordx4 v8, s[48:51], s53 offen offset:0 nt lds
    v_add_u32 v17, -2, v20
    ds_write_b32 v15, v17
    s_waitcnt vmcnt(20)
    buffer_load_dwordx4 v9, s[48:51], s53 offen offset:1024 nt lds
    s_waitcnt vmcnt(20)
    buffer_load_dwordx4 v8, s[48:51], s53 offen offset:2048 nt lds
    s_waitcnt vmcnt(20)
    buffer_load_dwordx4 v9, s[48:51], s53 offen offset:3072 nt lds
    s_add_u32 m0, s54, 8192
    s_add_u32 s53, s52, 8192
    s_waitcnt vmcnt(20)
    buffer_load_dwordx4 v8, s[48:51], s53 offen offset:0 nt lds
    s_waitcnt vmcnt(20)
    buffer_load_dwordx4 v9, s[48:51], s53 offen offset:1024 nt lds
    s_waitcnt vmcnt(20)
    buffer_load_dwordx4 v8, s[48:51], s53 offen offset:2048 nt lds
    ds_read2_b32 v[18:19], v16 offset1:64
    s_waitcnt vmcnt(20)
    buffer_load_dwordx4 v9, s[48:51], s53 offen offset:3072 nt lds
    s_add_u32 m0, s54, 12288
    s_add_u32 s53, s52, 12288
    s_waitcnt vmcnt(20)
    buffer_load_dwordx4 v8, s[48:51], s53 offen offset:0 nt lds
    v_add_u32 v17, -1, v20
    ds_write_b32 v15, v17
    s_waitcnt vmcnt(20)
    buffer_load_dwordx4 v9, s[48:51], s53 offen offset:1024 nt lds
    s_waitcnt lgkmcnt(0)
    v_readfirstlane_b32 s56, v18
    v_readfirstlane_b32 s39, v19
    s_add_u32 s54, s54, 16384
    s_cmp_eq_u32 s54, 149504
    s_cselect_b32 s54, 2048, s54
    s_add_u32 s55, s55, 1
    s_waitcnt vmcnt(20)
    buffer_load_dwordx4 v8, s[48:51], s53 offen offset:2048 nt lds
    s_add_u32 s52, s52, 16384
    s_add_u32 s38, s38, 1
    s_cmp_eq_u32 s39, 21
    s_cselect_b32 s34, s38, 32
    s_bitcmp1_b64 s[40:41], s34
    s_waitcnt vmcnt(20)
    buffer_load_dwordx4 v9, s[48:51], s53 offen offset:3072 nt lds
    v_add_u32 v20, 2, v20
    s_cbranch_scc0 L_w21
    s_branch L_rare
L_w23:
    s_cmp_lt_i32 s56, s55
    s_cbranch_scc1 L_slow25
L_back26:
    s_add_u32 m0, s54, 0
    s_add_u32 s53, s52, 0
    s_waitcnt vmcnt(22)
    buffer_load_dwordx4 v4, s[44:47], s53 offen offset:0 nt lds
    s_waitcnt vmcnt(22)
    buffer_load_dwordx4 v5, s[44:47], s53 offen offset:1024 nt lds
    s_waitcnt vmcnt(22)
    buffer_load_dwordx4 v6, s[44:47], s53 offen offset:2048 nt lds
    s_waitcnt vmcnt(22)
    buffer_load_dwordx4 v7, s[44:47], s53 offen offset:3072 nt lds
    s_add_u32 m0, s54, 4096
    s_add_u32 s53, s52, 4096
    s_waitcnt vmcnt(22)
    buffer_load_dwordx4 v4, s[44:47], s53 offen offset:0 nt lds
    s_waitcnt vmcnt(22)
    buffer_load_dwordx4 v5, s[44:47], s53 offen offset:1024 nt lds
    s_waitcnt vmcnt(22)
    buffer_load_dwordx4 v6, s[44:47], s53 offen offset:2048 nt lds
    v_add_u32 v17, -2, v20
    ds_write_b32 v15, v17
    s_waitcnt vmcnt(22)
    buffer_load_dwordx4 v7, s[44:47], s53 offen offset:3072 nt lds
    s_add_u32 m0, s54, 8192
    s_add_u32 s53, s52, 8192
    s_waitcnt vmcnt(22)
    buffer_load_dwordx4 v4, s[44:47], s53 offen offset:0 nt lds
    s_waitcnt vmcnt(22)
    buffer_load_dwordx4 v5, s[44:47], s53 offen offset:1024 nt lds
    s_waitcnt vmcnt(22)
    buffer_load_dwordx4 v6, s[44:47], s53 offen offset:2048 nt lds
    ds_read_b32 v18, v16
    s_waitcnt vmcnt(22)
    buffer_load_dwordx4 v7, s[44:47], s53 offen offset:3072 nt lds
    s_add_u32 m0, s54, 12288
    s_add_u32 s53, s52, 12288
    s_waitcnt vmcnt(22)
    buffer_load_dwordx4 v4, s[44:47], s53 offen offset:0 nt lds
    s_waitcnt vmcnt(22)
    buffer_load_dwordx4 v5, s[44:47], s53 offen offset:1024 nt lds
    s_waitcnt lgkmcnt(0)
    v_readfirstlane_b32 s56, v18
    s_add_u32 s54, s54, 16384
    s_cmp_eq_u32 s54, 149504
    s_cselect_b32 s54, 2048, s54
    s_add_u32 s55, s55, 1
    s_waitcnt vmcnt(22)
    buffer_load_dwordx4 v6, s[44:47], s53 offen offset:2048 nt lds
    v_add_u32 v17, -1, v20
    ds_write_b32 v15, v17
    s_waitcnt vmcnt(22)
    buffer_load_dwordx4 v7, s[44:47], s53 offen offset:3072 nt lds
    v_add_u32 v20, 2, v20
    s_cmp_lt_i32 s56, s55
    s_cbranch_scc1 L_slow27
L_back28:
    s_add_u32 m0, s54, 0
    s_add_u32 s53, s52, 0
    s_waitcnt vmcnt(22)
    buffer_load_dwordx4 v8, s[48:51], s53 offen offset:0 nt lds
    s_waitcnt vmcnt(22)
    buffer_load_dwordx4 v9, s[48:51], s53 offen offset:1024 nt lds
    s_waitcnt vmcnt(22)
    buffer_load_dwordx4 v8, s[48:51], s53 offen offset:2048 nt lds
    s_waitcnt vmcnt(22)
    buffer_load_dwordx4 v9, s[48:51], s53 offen offset:3072 nt lds
    s_add_u32 m0, s54, 4096
    s_add_u32 s53, s52, 4096
    s_waitcnt vmcnt(22)
    buffer_load_dwordx4 v8, s[48:51], s53 offen offset:0 nt lds
    s_waitcnt vmcnt(22)
    buffer_load_dwordx4 v9, s[48:51], s53 offen offset:1024 nt lds
    s_waitcnt vmcnt(22)
    buffer_load_dwordx4 v8, s[48:51], s53 offen offset:2048 nt lds
    v_add_u32 v17, -2, v20
    ds_write_b32 v15, v17
    s_waitcnt vmcnt(22)
    buffer_load_dwordx4 v9, s[48:51], s53 offen offset:3072 nt lds
    s_add_u32 m0, s54, 8192
    s_add_u32 s53, s52, 8192
    s_waitcnt vmcnt(22)
    buffer_load_dwordx4 v8, s[48:51], s53 offen offset:0 nt lds
    s_waitcnt vmcnt(22)
    buffer_load_dwordx4 v9, s[48:51], s53 offen offset:1024 nt lds
    s_waitcnt vmcnt(22)
    buffer_load_dwordx4 v8, s[48:51], s53 offen offset:2048 nt lds
    ds_read2_b32 v[18:19], v16 offset1:64
    s_waitcnt vmcnt(22)
    buffer_load_dwordx4 v9, s[48:51], s53 offen offset:3072 nt lds
    s_add_u32 m0, s54, 12288
    s_add_u32 s53, s52, 12288
    s_waitcnt vmcnt(22)
    buffer_load_dwordx4 v8, s[48:51], s53 offen offset:0 nt lds
    s_waitcnt vmcnt(22)
    buffer_load_dwordx4 v9, s[48:51], s53 offen offset:1024 nt lds
    s_waitcnt lgkmcnt(0)
    v_readfirstlane_b32 s56, v18
    v_readfirstlane_b32 s39, v19
    s_add_u32 s54, s54, 16384
    s_cmp_eq_u32 s54, 149504
    s_cselect_b32 s54, 2048, s54
    s_add_u32 s55, s55, 1
    s_waitcnt vmcnt(22)
    buffer_load_dwordx4 v8, s[48:51], s53 offen offset:2048 nt lds
    v_add_u32 v17, -1, v20
    ds_write_b32 v15, v17
    s_add_u32 s52, s52, 16384
    s_add_u32 s38, s38, 1
    s_cmp_eq_u32 s39, 23
    s_cselect_b32 s34, s38, 32
    s_bitcmp1_b64 s[40:41], s34
    s_waitcnt vmcnt(22)
    buffer_load_dwordx4 v9, s[48:51], s53 offen offset:3072 nt lds
    v_add_u32 v20, 2, v20
    s_cbranch_scc0 L_w23
    s_branch L_rare
L_w26:
    s_cmp_lt_i32 s56, s55
    s_cbranch_scc1 L_slow29
L_back30:
    s_add_u32 m0, s54, 0
    s_add_u32 s53, s52, 0
    s_waitcnt vmcnt(25)
    buffer_load_dwordx4 v4, s[44:47], s53 offen offset:0 nt lds
    s_waitcnt vmcnt(25)
    buffer_load_dwordx4 v5, s[44:47], s53 offen offset:1024 nt lds
    v_add_u32 v17, -3, v20
    ds_write_b32 v15, v17
    s_waitcnt vmcnt(25)
    buffer_load_dwordx4 v6, s[44:47], s53 offen offset:2048 nt lds
    s_waitcnt vmcnt(25)
    buffer_load_dwordx4 v7, s[44:47], s53 offen offset:3072 nt lds
    s_add_u32 m0, s54, 4096
    s_add_u32 s53, s52, 4096
    s_waitcnt vmcnt(25)
    buffer_load_dwordx4 v4, s[44:47], s53 offen offset:0 nt lds
    s_waitcnt vmcnt(25)
    buffer_load_dwordx4 v5, s[44:47], s53 offen offset:1024 nt lds
    s_waitcnt vmcnt(25)
    buffer_load_dwordx4 v6, s[44:47], s53 offen offset:2048 nt lds
    s_waitcnt vmcnt(25)
    buffer_load_dwordx4 v7, s[44:47], s53 offen offset:3072 nt lds
    s_add_u32 m0, s54, 8192
    s_add_u32 s53, s52, 8192
    s_waitcnt vmcnt(25)
    buffer_load_dwordx4 v4, s[44:47], s53 offen offset:0 nt lds
    s_waitcnt vmcnt(25)
    buffer_load_dwordx4 v5, s[44:47], s53 offen offset:1024 nt lds
    v_add_u32 v17, -2, v20
    ds_write_b32 v15, v17
    s_waitcnt vmcnt(25)
    buffer_load_dwordx4 v6, s[44:47], s53 offen offset:2048 nt lds
    ds_read_b32 v18, v16
    s_waitcnt vmcnt(25)
    buffer_load_dwordx4 v7, s[44:47], s53 offen offset:3072 nt lds
    s_add_u32 m0, s54, 12288
    s_add_u32 s53, s52, 12288
    s_waitcnt vmcnt(25)
    buffer_load_dwordx4 v4, s[44:47], s53 offen offset:0 nt lds
    s_waitcnt vmcnt(25)
    buffer_load_dwordx4 v5, s[44:47], s53 offen offset:1024 nt lds
    s_waitcnt lgkmcnt(0)
    v_readfirstlane_b32 s56, v18
    s_add_u32 s54, s54, 16384
    s_cmp_eq_u32 s54, 149504
    s_cselect_b32 s54, 2048, s54
    s_add_u32 s55, s55, 1
    s_waitcnt vmcnt(25)
    buffer_load_dwordx4 v6, s[44:47], s53 offen offset:2048 nt lds
    s_waitcnt vmcnt(25)
    buffer_load_dwordx4 v7, s[44:47], s53 offen offset:3072 nt lds
    v_add_u32 v20, 2, v20
    s_cmp_lt_i32 s56, s55
    s_cbranch_scc1 L_slow31
L_back32:
    s_add_u32 m0, s54, 0
    s_add_u32 s53, s52, 0
    s_waitcnt vmcnt(25)
    buffer_load_dwordx4 v8, s[48:51], s53 offen offset:0 nt lds
    s_waitcnt vmcnt(25)
    buffer_load_dwordx4 v9, s[48:51], s53 offen offset:1024 nt lds
    v_add_u32 v17, -3, v20
    ds_write_b32 v15, v17
    s_waitcnt vmcnt(25)
    buffer_load_dwordx4 v8, s[48:51], s53 offen offset:2048 nt lds
    s_waitcnt vmcnt(25)
    buffer_load_dwordx4 v9, s[48:51], s53 offen offset:3072 nt lds
    s_add_u32 m0, s54, 4096
    s_add_u32 s53, s52, 4096
    s_waitcnt vmcnt(25)
    buffer_load_dwordx4 v8, s[48:51], s53 offen offset:0 nt lds
    s_waitcnt vmcnt(25)
    buffer_load_dwordx4 v9, s[48:51], s53 offen offset:1024 nt lds
    s_waitcnt vmcnt(25)
    buffer_load_dwordx4 v8, s[48:51], s53 offen offset:2048 nt lds
    s_waitcnt vmcnt(25)
    buffer_load_dwordx4 v9, s[48:51], s53 offen offset:3072 nt lds
    s_add_u32 m0, s54, 8192
    s_add_u32 s53, s52, 8192
    s_waitcnt vmcnt(25)
    buffer_load_dwordx4 v8, s[48:51], s53 offen offset:0 nt lds
    s_waitcnt vmcnt(25)
    buffer_load_dwordx4 v9, s[48:51], s53 offen offset:1024 nt lds
    v_add_u32 v17, -2, v20
    ds_write_b32 v15, v17
    s_waitcnt vmcnt(25)
    buffer_load_dwordx4 v8, s[48:51], s53 offen offset:2048 nt lds
    ds_read2_b32 v[18:19], v16 offset1:64
    s_waitcnt vmcnt(25)
    buffer_load_dwordx4 v9, s[48:51], s53 offen offset:3072 nt lds
    s_add_u32 m0, s54, 12288
    s_add_u32 s53, s52, 12288
    s_waitcnt vmcnt(25)
    buffer_load_dwordx4 v8, s[48:51], s53 offen offset:0 nt lds
    s_waitcnt vmcnt(25)
    buffer_load_dwordx4 v9, s[48:51], s53 offen offset:1024 nt lds
    s_waitcnt lgkmcnt(0)
    v_readfirstlane_b32 s56, v18
    v_readfirstlane_b32 s39, v19
    s_add_u32 s54, s54, 16384
    s_cmp_eq_u32 s54, 149504
    s_cselect_b32 s54, 2048, s54
    s_add_u32 s55, s55, 1
    s_waitcnt vmcnt(25)
    buffer_load_dwordx4 v8, s[48:51], s53 offen offset:2048 nt lds
    s_add_u32 s52, s52, 16384
    s_add_u32 s38, s38, 1
    s_cmp_eq_u32 s39, 26
    s_cselect_b32 s34, s38, 32
    s_bitcmp1_b64 s[40:41], s34
    s_waitcnt vmcnt(25)
    buffer_load_dwordx4 v9, s[48:51], s53 offen offset:3072 nt lds
    v_add_u32 v20, 2, v20
    s_cbranch_scc0 L_w26
    s_branch L_rare
L_w30:
    s_cmp_lt_i32 s56, s55
    s_cbranch_scc1 L_slow33
L_back34:
    s_add_u32 m0, s54, 0
    s_add_u32 s53, s52, 0
    s_waitcnt vmcnt(29)
    buffer_load_dwordx4 v4, s[44:47], s53 offen offset:0 nt lds
    s_waitcnt vmcnt(29)
    buffer_load_dwordx4 v5, s[44:47], s53 offen offset:1024 nt lds
    s_waitcnt vmcnt(29)
    buffer_load_dwordx4 v6, s[44:47], s53 offen offset:2048 nt lds
    s_waitcnt vmcnt(29)
    buffer_load_dwordx4 v7, s[44:47], s53 offen offset:3072 nt lds
    s_add_u32 m0, s54, 4096
    s_add_u32 s53, s52, 4096
    s_waitcnt vmcnt(29)
    buffer_load_dwordx4 v4, s[44:47], s53 offen offset:0 nt lds
    s_waitcnt vmcnt(29)
    buffer_load_dwordx4 v5, s[44:47], s53 offen offset:1024 nt lds
    v_add_u32 v17, -3, v20
    ds_write_b32 v15, v17
    s_waitcnt vmcnt(29)
    buffer_load_dwordx4 v6, s[44:47], s53 offen offset:2048 nt lds
    s_waitcnt vmcnt(29)
    buffer_load_dwordx4 v7, s[44:47], s53 offen offset:3072 nt lds
    s_add_u32 m0, s54, 8192
    s_add_u32 s53, s52, 8192
    s_waitcnt vmcnt(29)
    buffer_load_dwordx4 v4, s[44:47], s53 offen offset:0 nt lds
    s_waitcnt vmcnt(29)
    buffer_load_dwordx4 v5, s[44:47], s53 offen offset:1024 nt lds
    s_waitcnt vmcnt(29)
    buffer_load_dwordx4 v6, s[44:47], s53 offen offset:2048 nt lds
    ds_read_b32 v18, v16
    s_waitcnt vmcnt(29)
    buffer_load_dwordx4 v7, s[44:47], s53 offen offset:3072 nt lds
    s_add_u32 m0, s54, 12288
    s_add_u32 s53, s52, 12288
    s_waitcnt vmcnt(29)
    buffer_load_dwordx4 v4, s[44:47], s53 offen offset:0 nt lds
    s_waitcnt vmcnt(29)
    buffer_load_dwordx4 v5, s[44:47], s53 offen offset:1024 nt lds
    v_add_u32 v17, -2, v20
    ds_write_b32 v15, v17
    s_waitcnt lgkmcnt(0)
    v_readfirstlane_b32 s56, v18
    s_add_u32 s54, s54, 16384
    s_cmp_eq_u32 s54, 149504
    s_cselect_b32 s54, 2048, s54
    s_add_u32 s55, s55, 1
    s_waitcnt vmcnt(29)
    buffer_load_dwordx4 v6, s[44:47], s53 offen offset:2048 nt lds
    s_waitcnt vmcnt(29)
    buffer_load_dwordx4 v7, s[44:47], s53 offen offset:3072 nt lds
    v_add_u32 v20, 2, v20
    s_cmp_lt_i32 s56, s55
    s_cbranch_scc1 L_slow35
L_back36:
    s_add_u32 m0, s54, 0
    s_add_u32 s53, s52, 0
    s_waitcnt vmcnt(29)
    buffer_load_dwordx4 v8, s[48:51], s53 offen offset:0 nt lds
    s_waitcnt vmcnt(29)
    buffer_load_dwordx4 v9, s[48:51], s53 offen offset:1024 nt lds
    s_waitcnt vmcnt(29)
    buffer_load_dwordx4 v8, s[48:51], s53 offen offset:2048 nt lds
    s_waitcnt vmcnt(29)
    buffer_load_dwordx4 v9, s[48:51], s53 offen offset:3072 nt lds
    s_add_u32 m0, s54, 4096
    s_add_u32 s53, s52, 4096
    s_waitcnt vmcnt(29)
    buffer_load_dwordx4 v8, s[48:51], s53 offen offset:0 nt lds
    s_waitcnt vmcnt(29)
    buffer_load_dwordx4 v9, s[48:51], s53 offen offset:1024 nt lds
    v_add_u32 v17, -3, v20
    ds_write_b32 v15, v17
    s_waitcnt vmcnt(29)
    buffer_load_dwordx4 v8, s[48:51], s53 offen offset:2048 nt lds
    s_waitcnt vmcnt(29)
    buffer_load_dwordx4 v9, s[48:51], s53 offen offset:3072 nt lds
    s_add_u32 m0, s54, 8192
    s_add_u32 s53, s52, 8192
    s_waitcnt vmcnt(29)
    buffer_load_dwordx4 v8, s[48:51], s53 offen offset:0 nt lds
    s_waitcnt vmcnt(29)
    buffer_load_dwordx4 v9, s[48:51], s53 offen offset:1024 nt lds
    s_waitcnt vmcnt(29)
    buffer_load_dwordx4 v8, s[48:51], s53 offen offset:2048 nt lds
    ds_read2_b32 v[18:19], v16 offset1:64
    s_waitcnt vmcnt(29)
    buffer_load_dwordx4 v9, s[48:51], s53 offen offset:3072 nt lds
    s_add_u32 m0, s54, 12288
    s_add_u32 s53, s52, 12288
    s_waitcnt vmcnt(29)
    buffer_load_dwordx4 v8, s[48:51], s53 offen offset:0 nt lds
    s_waitcnt vmcnt(29)
    buffer_load_dwordx4 v9, s[48:51], s53 offen offset:1024 nt lds
    v_add_u32 v17, -2, v20
    ds_write_b32 v15, v17
    s_waitcnt lgkmcnt(0)
    v_readfirstlane_b32 s56, v18
    v_readfirstlane_b32 s39, v19
    s_add_u32 s54, s54, 16384
    s_cmp_eq_u32 s54, 149504
    s_cselect_b32 s54, 2048, s54
    s_add_u32 s55, s55, 1
    s_waitcnt vmcnt(29)
    buffer_load_dwordx4 v8, s[48:51], s53 offen offset:2048 nt lds
    s_add_u32 s52, s52, 16384
    s_add_u32 s38, s38, 1
    s_cmp_eq_u32 s39, 30
    s_cselect_b32 s34, s38, 32
    s_bitcmp1_b64 s[40:41], s34
    s_waitcnt vmcnt(29)
    buffer_load_dwordx4 v9, s[48:51], s53 offen offset:3072 nt lds
    v_add_u32 v20, 2, v20
    s_cbranch_scc0 L_w30
    s_branch L_rare
L_slow1:
    s_sub_u32 s33, s33, 1
    s_cbranch_scc1 L_end
    ds_read_b32 v18, v16
    s_waitcnt lgkmcnt(0)
    v_readfirstlane_b32 s56, v18
    s_cmp_lt_i32 s56, s55
    s_cbranch_scc1 L_slow1
    s_branch L_back2
L_slow3:
    s_sub_u32 s33, s33, 1
    s_cbranch_scc1 L_end
    ds_read_b32 v18, v16
    s_waitcnt lgkmcnt(0)
    v_readfirstlane_b32 s56, v18
    s_cmp_lt_i32 s56, s55
    s_cbranch_scc1 L_slow3
    s_branch L_back4
L_slow5:
    s_sub_u32 s33, s33, 1
    s_cbranch_scc1 L_end
    ds_read_b32 v18, v16
    s_waitcnt lgkmcnt(0)
    v_readfirstlane_b32 s56, v18
    s_cmp_lt_i32 s56, s55
    s_cbranch_scc1 L_slow5
    s_branch L_back6
L_slow7:
    s_sub_u32 s33, s33, 1
    s_cbranch_scc1 L_end
    ds_read_b32 v18, v16
    s_waitcnt lgkmcnt(0)
    v_readfirstlane_b32 s56, v18
    s_cmp_lt_i32 s56, s55
    s_cbranch_scc1 L_slow7
    s_branch L_back8
L_slow9:
    s_sub_u32 s33, s33, 1
    s_cbranch_scc1 L_end
    ds_read_b32 v18, v16
    s_waitcnt lgkmcnt(0)
    v_readfirstlane_b32 s56, v18
    s_cmp_lt_i32 s56, s55
    s_cbranch_scc1 L_slow9
    s_branch L_back10
L_slow11:
    s_sub_u32 s33, s33, 1
    s_cbranch_scc1 L_end
    ds_read_b32 v18, v16
    s_waitcnt lgkmcnt(0)
    v_readfirstlane_b32 s56, v18
    s_cmp_lt_i32 s56, s55
    s_cbranch_scc1 L_slow11
    s_branch L_back12
L_slow13:
    s_sub_u32 s33, s33, 1
    s_cbranch_scc1 L_end
    ds_read_b32 v18, v16
    s_waitcnt lgkmcnt(0)
    v_readfirstlane_b32 s56, v18
    s_cmp_lt_i32 s56, s55
    s_cbranch_scc1 L_slow13
    s_branch L_back14
L_slow15:
    s_sub_u32 s33, s33, 1
    s_cbranch_scc1 L_end
    ds_read_b32 v18, v16
    s_waitcnt lgkmcnt(0)
    v_readfirstlane_b32 s56, v18
    s_cmp_lt_i32 s56, s55
    s_cbranch_scc1 L_slow15
    s_branch L_back16
L_slow17:
    s_sub_u32 s33, s33, 1
    s_cbranch_scc1 L_end
    ds_read_b32 v18, v16
    s_waitcnt lgkmcnt(0)
    v_readfirstlane_b32 s56, v18
    s_cmp_lt_i32 s56, s55
    s_cbranch_scc1 L_slow17
    s_branch L_back18
L_slow19:
    s_sub_u32 s33, s33, 1
    s_cbranch_scc1 L_end
    ds_read_b32 v18, v16
    s_waitcnt lgkmcnt(0)
    v_readfirstlane_b32 s56, v18
    s_cmp_lt_i32 s56, s55
    s_cbranch_scc1 L_slow19
    s_branch L_back20
L_slow21:
    s_sub_u32 s33, s33, 1
    s_cbranch_scc1 L_end
    ds_read_b32 v18, v16
    s_waitcnt lgkmcnt(0)
    v_readfirstlane_b32 s56, v18
    s_cmp_lt_i32 s56, s55
    s_cbranch_scc1 L_slow21
    s_branch L_back22
L_slow23:
    s_sub_u32 s33, s33, 1
    s_cbranch_scc1 L_end
    ds_read_b32 v18, v16
    s_waitcnt lgkmcnt(0)
    v_readfirstlane_b32 s56, v18
    s_cmp_lt_i32 s56, s55
    s_cbranch_scc1 L_slow23
    s_branch L_back24
L_slow25:
    s_sub_u32 s33, s33, 1
    s_cbranch_scc1 L_end
    ds_read_b32 v18, v16
    s_waitcnt lgkmcnt(0)
    v_readfirstlane_b32 s56, v18
    s_cmp_lt_i32 s56, s55
    s_cbranch_scc1 L_slow25
    s_branch L_back26
L_slow27:
    s_sub_u32 s33, s33, 1
    s_cbranch_scc1 L_end
    ds_read_b32 v18, v16
    s_waitcnt lgkmcnt(0)
    v_readfirstlane_b32 s56, v18
    s_cmp_lt_i32 s56, s55
    s_cbranch_scc1 L_slow27
    s_branch L_back28
L_slow29:
    s_sub_u32 s33, s33, 1
    s_cbranch_scc1 L_end
    ds_read_b32 v18, v16
    s_waitcnt lgkmcnt(0)
    v_readfirstlane_b32 s56, v18
    s_cmp_lt_i32 s56, s55
    s_cbranch_scc1 L_slow29
    s_branch L_back30
L_slow31:
    s_sub_u32 s33, s33, 1
    s_cbranch_scc1 L_end
    ds_read_b32 v18, v16
    s_waitcnt lgkmcnt(0)
    v_readfirstlane_b32 s56, v18
    s_cmp_lt_i32 s56, s55
    s_cbranch_scc1 L_slow31
    s_branch L_back32
L_slow33:
    s_sub_u32 s33, s33, 1
    s_cbranch_scc1 L_end
    ds_read_b32 v18, v16
    s_waitcnt lgkmcnt(0)
    v_readfirstlane_b32 s56, v18
    s_cmp_lt_i32 s56, s55
    s_cbranch_scc1 L_slow33
    s_branch L_back34
L_slow35:
    s_sub_u32 s33, s33, 1
    s_cbranch_scc1 L_end
    ds_read_b32 v18, v16
    s_waitcnt lgkmcnt(0)
    v_readfirstlane_b32 s56, v18
    s_cmp_lt_i32 s56, s55
    s_cbranch_scc1 L_slow35
    s_branch L_back36
L_attn:
    v_lshlrev_b32 v217, 2, v0
    v_add_u32 v217, 1280, v217
    v_mov_b32 v218, 0
    v_mov_b32 v216, 1024
    ds_write_b32 v217, v218
    v_lshlrev_b32 v226, 4, v0
    s_mov_b32 s52, -64
    s_mov_b32 s53, 2
    s_mov_b32 s54, 2048
    s_mov_b32 s44, 0xfffffc00
    s_waitcnt lgkmcnt(0)
    s_cmp_eq_u32 s32, 0
    s_cbranch_scc1 L_nox
    global_load_dwordx4 v[168:171], v226, s[4:5]
L_nox:
    s_load_dword s58, s[28:29], 0x8000
    s_barrier
    s_mov_b32 s36, s28
    s_mov_b32 s37, s29
    s_mov_b32 s38, 3145728
    s_mov_b32 s39, 0x00020000
    s_cmp_eq_u32 s32, 0
    s_cbranch_scc1 L_qw0
    s_cmp_eq_u32 s32, 4
    s_cbranch_scc1 L_nob
    s_lshl_b32 s34, s15, 7
    v_lshlrev_b32 v219, 3, v2
    v_add_u32 v219, s34, v219
    global_load_dwordx2 v[208:209], v219, s[18:19] offset:0
    global_load_dwordx2 v[210:211], v219, s[18:19] offset:32
    global_load_dwordx2 v[212:213], v219, s[18:19] offset:64
    global_load_dwordx2 v[214:215], v219, s[18:19] offset:96
L_nob:
    v_lshrrev_b32 v219, 2, v0
    v_lshlrev_b32 v219, 7, v219
    v_and_b32 v220, 3, v0
    v_lshl_add_u32 v219, v220, 3, v219
    v_bfe_u32 v220, v0, 3, 2
    v_xor_b32 v196, 0, v220
    v_lshl_add_u32 v196, v196, 5, v219
    v_xor_b32 v197, 1, v220
    v_lshl_add_u32 v197, v197, 5, v219
    v_xor_b32 v198, 2, v220
    v_lshl_add_u32 v198, v198, 5, v219
    v_xor_b32 v199, 3, v220
    v_lshl_add_u32 v199, v199, 5, v219
    s_waitcnt vmcnt(0)
    v_and_b32 v133, 0xffff0000, v168
    v_lshlrev_b32 v132, 16, v168
    v_and_b32 v135, 0xffff0000, v169
    v_lshlrev_b32 v134, 16, v169
    v_and_b32 v137, 0xffff0000, v170
    v_lshlrev_b32 v136, 16, v170
    v_and_b32 v139, 0xffff0000, v171
    v_lshlrev_b32 v138, 16, v171
    v_add_f32 v140, v132, v136
    v_add_f32 v141, v133, v137
    v_add_f32 v142, v134, v138
    v_add_f32 v143, v135, v139
    v_add_f32 v140, v140, v142
    v_add_f32 v141, v141, v143
    v_add_f32 v148, v140, v141
    s_nop 1
    v_add_f32_dpp v148, v148, v148 row_ror:1 row_mask:0xf bank_mask:0xf
    s_nop 1
    v_add_f32_dpp v148, v148, v148 row_ror:2 row_mask:0xf bank_mask:0xf
    s_nop 1
    v_add_f32_dpp v148, v148, v148 row_ror:4 row_mask:0xf bank_mask:0xf
    s_nop 1
    v_add_f32_dpp v148, v148, v148 row_ror:8 row_mask:0xf bank_mask:0xf
    v_mov_b32 v150, v148
    s_nop 1
    v_permlane16_swap_b32 v148, v150
    v_add_f32 v148, v148, v150
    v_mov_b32 v150, v148
    s_nop 1
    v_permlane32_swap_b32 v148, v150
    v_add_f32 v148, v148, v150
    v_mul_f32 v148, 0x3b000000, v148
    v_sub_f32 v140, v132, v148
    v_sub_f32 v141, v133, v148
    v_sub_f32 v142, v134, v148
    v_sub_f32 v143, v135, v148
    v_sub_f32 v144, v136, v148
    v_sub_f32 v145, v137, v148
    v_sub_f32 v146, v138, v148
    v_sub_f32 v147, v139, v148
    v_mul_f32 v149, v140, v140
    v_mul_f32 v150, v141, v141
    v_fmac_f32 v149, v142, v142
    v_fmac_f32 v150, v143, v143
    v_fmac_f32 v149, v144, v144
    v_fmac_f32 v150, v145, v145
    v_fmac_f32 v149, v146, v146
    v_fmac_f32 v150, v147, v147
    v_add_f32 v149, v149, v150
    s_nop 1
    v_add_f32_dpp v149, v149, v149 row_ror:1 row_mask:0xf bank_mask:0xf
    s_nop 1
    v_add_f32_dpp v149, v149, v149 row_ror:2 row_mask:0xf bank_mask:0xf
    s_nop 1
    v_add_f32_dpp v149, v149, v149 row_ror:4 row_mask:0xf bank_mask:0xf
    s_nop 1
    v_add_f32_dpp v149, v149, v149 row_ror:8 row_mask:0xf bank_mask:0xf
    v_mov_b32 v150, v149
    s_nop 1
    v_permlane16_swap_b32 v149, v150
    v_add_f32 v149, v149, v150
    v_mov_b32 v150, v149
    s_nop 1
    v_permlane32_swap_b32 v149, v150
    v_add_f32 v149, v149, v150
    v_mul_f32 v149, 0x3b000000, v149
    v_cvt_pk_bf16_f32 v148, v148, v148
    v_lshlrev_b32 v148, 16, v148
    v_cvt_pk_bf16_f32 v149, v149, v149
    v_lshlrev_b32 v149, 16, v149
    v_add_f32 v149, 0x3727c5ac, v149
    v_cvt_pk_bf16_f32 v149, v149, v149
    v_lshlrev_b32 v149, 16, v149
    v_sqrt_f32 v149, v149
    v_sub_f32 v140, v132, v148
    v_sub_f32 v141, v133, v148
    v_sub_f32 v142, v134, v148
    v_sub_f32 v143, v135, v148
    v_sub_f32 v144, v136, v148
    v_sub_f32 v145, v137, v148
    v_sub_f32 v146, v138, v148
    v_sub_f32 v147, v139, v148
    v_cvt_pk_bf16_f32 v149, v149, v149
    v_lshlrev_b32 v149, 16, v149
    v_rcp_f32 v149, v149
    v_cvt_pk_bf16_f32 v168, v140, v141
    v_cvt_pk_bf16_f32 v169, v142, v143
    v_cvt_pk_bf16_f32 v170, v144, v145
    v_cvt_pk_bf16_f32 v171, v146, v147
    v_and_b32 v141, 0xffff0000, v168
    v_lshlrev_b32 v140, 16, v168
    v_and_b32 v143, 0xffff0000, v169
    v_lshlrev_b32 v142, 16, v169
    v_and_b32 v145, 0xffff0000, v170
    v_lshlrev_b32 v144, 16, v170
    v_and_b32 v147, 0xffff0000, v171
    v_lshlrev_b32 v146, 16, v171
    v_mul_f32 v140, v140, v149
    v_mul_f32 v141, v141, v149
    v_mul_f32 v142, v142, v149
    v_mul_f32 v143, v143, v149
    v_mul_f32 v144, v144, v149
    v_mul_f32 v145, v145, v149
    v_mul_f32 v146, v146, v149
    v_mul_f32 v147, v147, v149
    v_cvt_pk_bf16_f32 v168, v140, v141
    v_cvt_pk_bf16_f32 v169, v142, v143
    v_cvt_pk_bf16_f32 v170, v144, v145
    v_cvt_pk_bf16_f32 v171, v146, v147
    ds_write_b128 v226, v[168:171] offset:0
    v_lshlrev_b32 v220, 3, v2
    s_waitcnt lgkmcnt(0)
    ds_read2_b64 v[4:7], v220 offset0:0 offset1:4
    ds_read2_b64 v[8:11], v220 offset0:8 offset1:12
    ds_read2_b64 v[12:15], v220 offset0:16 offset1:20
    ds_read2_b64 v[16:19], v220 offset0:24 offset1:28
    ds_read2_b64 v[20:23], v220 offset0:32 offset1:36
    ds_read2_b64 v[24:27], v220 offset0:40 offset1:44
    ds_read2_b64 v[28:31], v220 offset0:48 offset1:52
    ds_read2_b64 v[32:35], v220 offset0:56 offset1:60
    ds_read2_b64 v[36:39], v220 offset0:64 offset1:68
    ds_read2_b64 v[40:43], v220 offset0:72 offset1:76
    ds_read2_b64 v[44:47], v220 offset0:80 offset1:84
    ds_read2_b64 v[48:51], v220 offset0:88 offset1:92
    ds_read2_b64 v[52:55], v220 offset0:96 offset1:100
    ds_read2_b64 v[56:59], v220 offset0:104 offset1:108
    ds_read2_b64 v[60:63], v220 offset0:112 offset1:116
    ds_read2_b64 v[64:67], v220 offset0:120 offset1:124
    s_waitcnt lgkmcnt(0)
    v_add_u32 v184, s54, v196
    v_add_u32 v185, s54, v197
    v_add_u32 v186, s54, v198
    v_add_u32 v187, s54, v199
    s_add_u32 s54, s54, 16384
    s_cmp_eq_u32 s54, 149504
    s_cselect_b32 s54, 2048, s54
    s_cmp_ge_i32 s52, s53
    s_cbranch_scc1 L_ok37
L_poll38:
    ds_read_b32 v219, v216
    s_sub_u32 s33, s33, 1
    s_cbranch_scc1 L_end
    s_waitcnt lgkmcnt(0)
    v_readfirstlane_b32 s52, v219
    s_cmp_lt_i32 s52, s53
    s_cbranch_scc1 L_poll38
L_ok37:
    ds_read_b64_tr_b16 v[68:69], v184 offset:0
    ds_read_b64_tr_b16 v[70:71], v184 offset:2048
    ds_read_b64_tr_b16 v[72:73], v185 offset:0
    ds_read_b64_tr_b16 v[74:75], v185 offset:2048
    ds_read_b64_tr_b16 v[76:77], v186 offset:0
    ds_read_b64_tr_b16 v[78:79], v186 offset:2048
    ds_read_b64_tr_b16 v[80:81], v187 offset:0
    ds_read_b64_tr_b16 v[82:83], v187 offset:2048
    ds_read_b64_tr_b16 v[84:85], v184 offset:4096
    ds_read_b64_tr_b16 v[86:87], v184 offset:6144
    ds_read_b64_tr_b16 v[88:89], v185 offset:4096
    ds_read_b64_tr_b16 v[90:91], v185 offset:6144
    s_waitcnt lgkmcnt(10)
    v_mfma_f32_16x16x32_bf16 v[132:135], v[68:71], v[4:7], 0
    ds_read_b64_tr_b16 v[92:93], v186 offset:4096
    ds_read_b64_tr_b16 v[94:95], v186 offset:6144
    s_waitcnt lgkmcnt(10)
    v_mfma_f32_16x16x32_bf16 v[136:139], v[72:75], v[4:7], 0
    ds_read_b64_tr_b16 v[96:97], v187 offset:4096
    ds_read_b64_tr_b16 v[98:99], v187 offset:6144
    s_waitcnt lgkmcnt(10)
    v_mfma_f32_16x16x32_bf16 v[140:143], v[76:79], v[4:7], 0
    ds_read_b64_tr_b16 v[100:101], v184 offset:8192
    ds_read_b64_tr_b16 v[102:103], v184 offset:10240
    s_waitcnt lgkmcnt(10)
    v_mfma_f32_16x16x32_bf16 v[144:147], v[80:83], v[4:7], 0
    ds_read_b64_tr_b16 v[104:105], v185 offset:8192
    ds_read_b64_tr_b16 v[106:107], v185 offset:10240
    s_waitcnt lgkmcnt(10)
    v_mfma_f32_16x16x32_bf16 v[132:135], v[84:87], v[8:11], v[132:135]
    ds_read_b64_tr_b16 v[108:109], v186 offset:8192
    ds_read_b64_tr_b16 v[110:111], v186 offset:10240
    s_waitcnt lgkmcnt(10)
    v_mfma_f32_16x16x32_bf16 v[136:139], v[88:91], v[8:11], v[136:139]
    ds_read_b64_tr_b16 v[112:113], v187 offset:8192
    ds_read_b64_tr_b16 v[114:115], v187 offset:10240
    s_waitcnt lgkmcnt(10)
    v_mfma_f32_16x16x32_bf16 v[140:143], v[92:95], v[8:11], v[140:143]
    ds_read_b64_tr_b16 v[116:117], v184 offset:12288
    ds_read_b64_tr_b16 v[118:119], v184 offset:14336
    s_waitcnt lgkmcnt(10)
    v_mfma_f32_16x16x32_bf16 v[144:147], v[96:99], v[8:11], v[144:147]
    ds_read_b64_tr_b16 v[120:121], v185 offset:12288
    ds_read_b64_tr_b16 v[122:123], v185 offset:14336
    s_waitcnt lgkmcnt(10)
    v_mfma_f32_16x16x32_bf16 v[132:135], v[100:103], v[12:15], v[132:135]
    ds_read_b64_tr_b16 v[124:125], v186 offset:12288
    ds_read_b64_tr_b16 v[126:127], v186 offset:14336
    s_waitcnt lgkmcnt(10)
    v_mfma_f32_16x16x32_bf16 v[136:139], v[104:107], v[12:15], v[136:139]
    ds_read_b64_tr_b16 v[128:129], v187 offset:12288
    ds_read_b64_tr_b16 v[130:131], v187 offset:14336
    s_waitcnt lgkmcnt(10)
    v_mfma_f32_16x16x32_bf16 v[140:143], v[108:111], v[12:15], v[140:143]
    s_waitcnt lgkmcnt(8)
    v_mfma_f32_16x16x32_bf16 v[144:147], v[112:115], v[12:15], v[144:147]
    s_waitcnt lgkmcnt(6)
    v_mfma_f32_16x16x32_bf16 v[132:135], v[116:119], v[16:19], v[132:135]
    s_waitcnt lgkmcnt(4)
    v_mfma_f32_16x16x32_bf16 v[136:139], v[120:123], v[16:19], v[136:139]
    s_waitcnt lgkmcnt(2)
    v_mfma_f32_16x16x32_bf16 v[140:143], v[124:127], v[16:19], v[140:143]
    s_waitcnt lgkmcnt(0)
    v_mfma_f32_16x16x32_bf16 v[144:147], v[128:131], v[16:19], v[144:147]
    v_add_u32 v218, 1, v218
    ds_write_b32 v217, v218
    s_add_u32 s53, s53, 2
    v_add_u32 v184, s54, v196
    v_add_u32 v185, s54, v197
    v_add_u32 v186, s54, v198
    v_add_u32 v187, s54, v199
    s_add_u32 s54, s54, 16384
    s_cmp_eq_u32 s54, 149504
    s_cselect_b32 s54, 2048, s54
    s_cmp_ge_i32 s52, s53
    s_cbranch_scc1 L_ok39
L_poll40:
    ds_read_b32 v219, v216
    s_sub_u32 s33, s33, 1
    s_cbranch_scc1 L_end
    s_waitcnt lgkmcnt(0)
    v_readfirstlane_b32 s52, v219
    s_cmp_lt_i32 s52, s53
    s_cbranch_scc1 L_poll40
L_ok39:
    ds_read_b64_tr_b16 v[68:69], v184 offset:0
    ds_read_b64_tr_b16 v[70:71], v184 offset:2048
    ds_read_b64_tr_b16 v[72:73], v185 offset:0
    ds_read_b64_tr_b16 v[74:75], v185 offset:2048
    ds_read_b64_tr_b16 v[76:77], v186 offset:0
    ds_read_b64_tr_b16 v[78:79], v186 offset:2048
    ds_read_b64_tr_b16 v[80:81], v187 offset:0
    ds_read_b64_tr_b16 v[82:83], v187 offset:2048
    ds_read_b64_tr_b16 v[84:85], v184 offset:4096
    ds_read_b64_tr_b16 v[86:87], v184 offset:6144
    ds_read_b64_tr_b16 v[88:89], v185 offset:4096
    ds_read_b64_tr_b16 v[90:91], v185 offset:6144
    s_waitcnt lgkmcnt(10)
    v_mfma_f32_16x16x32_bf16 v[132:135], v[68:71], v[20:23], v[132:135]
    ds_read_b64_tr_b16 v[92:93], v186 offset:4096
    ds_read_b64_tr_b16 v[94:95], v186 offset:6144
    s_waitcnt lgkmcnt(10)
    v_mfma_f32_16x16x32_bf16 v[136:139], v[72:75], v[20:23], v[136:139]
    ds_read_b64_tr_b16 v[96:97], v187 offset:4096
    ds_read_b64_tr_b16 v[98:99], v187 offset:6144
    s_waitcnt lgkmcnt(10)
    v_mfma_f32_16x16x32_bf16 v[140:143], v[76:79], v[20:23], v[140:143]
    ds_read_b64_tr_b16 v[100:101], v184 offset:8192
    ds_read_b64_tr_b16 v[102:103], v184 offset:10240
    s_waitcnt lgkmcnt(10)
    v_mfma_f32_16x16x32_bf16 v[144:147], v[80:83], v[20:23], v[144:147]
    ds_read_b64_tr_b16 v[104:105], v185 offset:8192
    ds_read_b64_tr_b16 v[106:107], v185 offset:10240
    s_waitcnt lgkmcnt(10)
    v_mfma_f32_16x16x32_bf16 v[132:135], v[84:87], v[24:27], v[132:135]
    ds_read_b64_tr_b16 v[108:109], v186 offset:8192
    ds_read_b64_tr_b16 v[110:111], v186 offset:10240
    s_waitcnt lgkmcnt(10)
    v_mfma_f32_16x16x32_bf16 v[136:139], v[88:91], v[24:27], v[136:139]
    ds_read_b64_tr_b16 v[112:113], v187 offset:8192
    ds_read_b64_tr_b16 v[114:115], v187 offset:10240
    s_waitcnt lgkmcnt(10)
    v_mfma_f32_16x16x32_bf16 v[140:143], v[92:95], v[24:27], v[140:143]
    ds_read_b64_tr_b16 v[116:117], v184 offset:12288
    ds_read_b64_tr_b16 v[118:119], v184 offset:14336
    s_waitcnt lgkmcnt(10)
    v_mfma_f32_16x16x32_bf16 v[144:147], v[96:99], v[24:27], v[144:147]
    ds_read_b64_tr_b16 v[120:121], v185 offset:12288
    ds_read_b64_tr_b16 v[122:123], v185 offset:14336
    s_waitcnt lgkmcnt(10)
    v_mfma_f32_16x16x32_bf16 v[132:135], v[100:103], v[28:31], v[132:135]
    ds_read_b64_tr_b16 v[124:125], v186 offset:12288
    ds_read_b64_tr_b16 v[126:127], v186 offset:14336
    s_waitcnt lgkmcnt(10)
    v_mfma_f32_16x16x32_bf16 v[136:139], v[104:107], v[28:31], v[136:139]
    ds_read_b64_tr_b16 v[128:129], v187 offset:12288
    ds_read_b64_tr_b16 v[130:131], v187 offset:14336
    s_waitcnt lgkmcnt(10)
    v_mfma_f32_16x16x32_bf16 v[140:143], v[108:111], v[28:31], v[140:143]
    s_waitcnt lgkmcnt(8)
    v_mfma_f32_16x16x32_bf16 v[144:147], v[112:115], v[28:31], v[144:147]
    s_waitcnt lgkmcnt(6)
    v_mfma_f32_16x16x32_bf16 v[132:135], v[116:119], v[32:35], v[132:135]
    s_waitcnt lgkmcnt(4)
    v_mfma_f32_16x16x32_bf16 v[136:139], v[120:123], v[32:35], v[136:139]
    s_waitcnt lgkmcnt(2)
    v_mfma_f32_16x16x32_bf16 v[140:143], v[124:127], v[32:35], v[140:143]
    s_waitcnt lgkmcnt(0)
    v_mfma_f32_16x16x32_bf16 v[144:147], v[128:131], v[32:35], v[144:147]
    v_add_u32 v218, 1, v218
    ds_write_b32 v217, v218
    s_add_u32 s53, s53, 2
    v_add_u32 v184, s54, v196
    v_add_u32 v185, s54, v197
    v_add_u32 v186, s54, v198
    v_add_u32 v187, s54, v199
    s_add_u32 s54, s54, 16384
    s_cmp_eq_u32 s54, 149504
    s_cselect_b32 s54, 2048, s54
    s_cmp_ge_i32 s52, s53
    s_cbranch_scc1 L_ok41
L_poll42:
    ds_read_b32 v219, v216
    s_sub_u32 s33, s33, 1
    s_cbranch_scc1 L_end
    s_waitcnt lgkmcnt(0)
    v_readfirstlane_b32 s52, v219
    s_cmp_lt_i32 s52, s53
    s_cbranch_scc1 L_poll42
L_ok41:
    ds_read_b64_tr_b16 v[68:69], v184 offset:0
    ds_read_b64_tr_b16 v[70:71], v184 offset:2048
    ds_read_b64_tr_b16 v[72:73], v185 offset:0
    ds_read_b64_tr_b16 v[74:75], v185 offset:2048
    ds_read_b64_tr_b16 v[76:77], v186 offset:0
    ds_read_b64_tr_b16 v[78:79], v186 offset:2048
    ds_read_b64_tr_b16 v[80:81], v187 offset:0
    ds_read_b64_tr_b16 v[82:83], v187 offset:2048
    ds_read_b64_tr_b16 v[84:85], v184 offset:4096
    ds_read_b64_tr_b16 v[86:87], v184 offset:6144
    ds_read_b64_tr_b16 v[88:89], v185 offset:4096
    ds_read_b64_tr_b16 v[90:91], v185 offset:6144
    s_waitcnt lgkmcnt(10)
    v_mfma_f32_16x16x32_bf16 v[132:135], v[68:71], v[36:39], v[132:135]
    ds_read_b64_tr_b16 v[92:93], v186 offset:4096
    ds_read_b64_tr_b16 v[94:95], v186 offset:6144
    s_waitcnt lgkmcnt(10)
    v_mfma_f32_16x16x32_bf16 v[136:139], v[72:75], v[36:39], v[136:139]
    ds_read_b64_tr_b16 v[96:97], v187 offset:4096
    ds_read_b64_tr_b16 v[98:99], v187 offset:6144
    s_waitcnt lgkmcnt(10)
    v_mfma_f32_16x16x32_bf16 v[140:143], v[76:79], v[36:39], v[140:143]
    ds_read_b64_tr_b16 v[100:101], v184 offset:8192
    ds_read_b64_tr_b16 v[102:103], v184 offset:10240
    s_waitcnt lgkmcnt(10)
    v_mfma_f32_16x16x32_bf16 v[144:147], v[80:83], v[36:39], v[144:147]
    ds_read_b64_tr_b16 v[104:105], v185 offset:8192
    ds_read_b64_tr_b16 v[106:107], v185 offset:10240
    s_waitcnt lgkmcnt(10)
    v_mfma_f32_16x16x32_bf16 v[132:135], v[84:87], v[40:43], v[132:135]
    ds_read_b64_tr_b16 v[108:109], v186 offset:8192
    ds_read_b64_tr_b16 v[110:111], v186 offset:10240
    s_waitcnt lgkmcnt(10)
    v_mfma_f32_16x16x32_bf16 v[136:139], v[88:91], v[40:43], v[136:139]
    ds_read_b64_tr_b16 v[112:113], v187 offset:8192
    ds_read_b64_tr_b16 v[114:115], v187 offset:10240
    s_waitcnt lgkmcnt(10)
    v_mfma_f32_16x16x32_bf16 v[140:143], v[92:95], v[40:43], v[140:143]
    ds_read_b64_tr_b16 v[116:117], v184 offset:12288
    ds_read_b64_tr_b16 v[118:119], v184 offset:14336
    s_waitcnt lgkmcnt(10)
    v_mfma_f32_16x16x32_bf16 v[144:147], v[96:99], v[40:43], v[144:147]
    ds_read_b64_tr_b16 v[120:121], v185 offset:12288
    ds_read_b64_tr_b16 v[122:123], v185 offset:14336
    s_waitcnt lgkmcnt(10)
    v_mfma_f32_16x16x32_bf16 v[132:135], v[100:103], v[44:47], v[132:135]
    ds_read_b64_tr_b16 v[124:125], v186 offset:12288
    ds_read_b64_tr_b16 v[126:127], v186 offset:14336
    s_waitcnt lgkmcnt(10)
    v_mfma_f32_16x16x32_bf16 v[136:139], v[104:107], v[44:47], v[136:139]
    ds_read_b64_tr_b16 v[128:129], v187 offset:12288
    ds_read_b64_tr_b16 v[130:131], v187 offset:14336
    s_waitcnt lgkmcnt(10)
    v_mfma_f32_16x16x32_bf16 v[140:143], v[108:111], v[44:47], v[140:143]
    s_waitcnt lgkmcnt(8)
    v_mfma_f32_16x16x32_bf16 v[144:147], v[112:115], v[44:47], v[144:147]
    s_waitcnt lgkmcnt(6)
    v_mfma_f32_16x16x32_bf16 v[132:135], v[116:119], v[48:51], v[132:135]
    s_waitcnt lgkmcnt(4)
    v_mfma_f32_16x16x32_bf16 v[136:139], v[120:123], v[48:51], v[136:139]
    s_waitcnt lgkmcnt(2)
    v_mfma_f32_16x16x32_bf16 v[140:143], v[124:127], v[48:51], v[140:143]
    s_waitcnt lgkmcnt(0)
    v_mfma_f32_16x16x32_bf16 v[144:147], v[128:131], v[48:51], v[144:147]
    v_add_u32 v218, 1, v218
    ds_write_b32 v217, v218
    s_add_u32 s53, s53, 2
    v_add_u32 v184, s54, v196
    v_add_u32 v185, s54, v197
    v_add_u32 v186, s54, v198
    v_add_u32 v187, s54, v199
    s_add_u32 s54, s54, 16384
    s_cmp_eq_u32 s54, 149504
    s_cselect_b32 s54, 2048, s54
    s_cmp_ge_i32 s52, s53
    s_cbranch_scc1 L_ok43
L_poll44:
    ds_read_b32 v219, v216
    s_sub_u32 s33, s33, 1
    s_cbranch_scc1 L_end
    s_waitcnt lgkmcnt(0)
    v_readfirstlane_b32 s52, v219
    s_cmp_lt_i32 s52, s53
    s_cbranch_scc1 L_poll44
L_ok43:
    ds_read_b64_tr_b16 v[68:69], v184 offset:0
    ds_read_b64_tr_b16 v[70:71], v184 offset:2048
    ds_read_b64_tr_b16 v[72:73], v185 offset:0
    ds_read_b64_tr_b16 v[74:75], v185 offset:2048
    ds_read_b64_tr_b16 v[76:77], v186 offset:0
    ds_read_b64_tr_b16 v[78:79], v186 offset:2048
    ds_read_b64_tr_b16 v[80:81], v187 offset:0
    ds_read_b64_tr_b16 v[82:83], v187 offset:2048
    ds_read_b64_tr_b16 v[84:85], v184 offset:4096
    ds_read_b64_tr_b16 v[86:87], v184 offset:6144
    ds_read_b64_tr_b16 v[88:89], v185 offset:4096
    ds_read_b64_tr_b16 v[90:91], v185 offset:6144
    s_waitcnt lgkmcnt(10)
    v_mfma_f32_16x16x32_bf16 v[132:135], v[68:71], v[52:55], v[132:135]
    ds_read_b64_tr_b16 v[92:93], v186 offset:4096
    ds_read_b64_tr_b16 v[94:95], v186 offset:6144
    s_waitcnt lgkmcnt(10)
    v_mfma_f32_16x16x32_bf16 v[136:139], v[72:75], v[52:55], v[136:139]
    ds_read_b64_tr_b16 v[96:97], v187 offset:4096
    ds_read_b64_tr_b16 v[98:99], v187 offset:6144
    s_waitcnt lgkmcnt(10)
    v_mfma_f32_16x16x32_bf16 v[140:143], v[76:79], v[52:55], v[140:143]
    ds_read_b64_tr_b16 v[100:101], v184 offset:8192
    ds_read_b64_tr_b16 v[102:103], v184 offset:10240
    s_waitcnt lgkmcnt(10)
    v_mfma_f32_16x16x32_bf16 v[144:147], v[80:83], v[52:55], v[144:147]
    ds_read_b64_tr_b16 v[104:105], v185 offset:8192
    ds_read_b64_tr_b16 v[106:107], v185 offset:10240
    s_waitcnt lgkmcnt(10)
    v_mfma_f32_16x16x32_bf16 v[132:135], v[84:87], v[56:59], v[132:135]
    ds_read_b64_tr_b16 v[108:109], v186 offset:8192
    ds_read_b64_tr_b16 v[110:111], v186 offset:10240
    s_waitcnt lgkmcnt(10)
    v_mfma_f32_16x16x32_bf16 v[136:139], v[88:91], v[56:59], v[136:139]
    ds_read_b64_tr_b16 v[112:113], v187 offset:8192
    ds_read_b64_tr_b16 v[114:115], v187 offset:10240
    s_waitcnt lgkmcnt(10)
    v_mfma_f32_16x16x32_bf16 v[140:143], v[92:95], v[56:59], v[140:143]
    ds_read_b64_tr_b16 v[116:117], v184 offset:12288
    ds_read_b64_tr_b16 v[118:119], v184 offset:14336
    s_waitcnt lgkmcnt(10)
    v_mfma_f32_16x16x32_bf16 v[144:147], v[96:99], v[56:59], v[144:147]
    ds_read_b64_tr_b16 v[120:121], v185 offset:12288
    ds_read_b64_tr_b16 v[122:123], v185 offset:14336
    s_waitcnt lgkmcnt(10)
    v_mfma_f32_16x16x32_bf16 v[132:135], v[100:103], v[60:63], v[132:135]
    ds_read_b64_tr_b16 v[124:125], v186 offset:12288
    ds_read_b64_tr_b16 v[126:127], v186 offset:14336
    s_waitcnt lgkmcnt(10)
    v_mfma_f32_16x16x32_bf16 v[136:139], v[104:107], v[60:63], v[136:139]
    ds_read_b64_tr_b16 v[128:129], v187 offset:12288
    ds_read_b64_tr_b16 v[130:131], v187 offset:14336
    s_waitcnt lgkmcnt(10)
    v_mfma_f32_16x16x32_bf16 v[140:143], v[108:111], v[60:63], v[140:143]
    s_waitcnt lgkmcnt(8)
    v_mfma_f32_16x16x32_bf16 v[144:147], v[112:115], v[60:63], v[144:147]
    s_waitcnt lgkmcnt(6)
    v_mfma_f32_16x16x32_bf16 v[132:135], v[116:119], v[64:67], v[132:135]
    s_waitcnt lgkmcnt(4)
    v_mfma_f32_16x16x32_bf16 v[136:139], v[120:123], v[64:67], v[136:139]
    s_waitcnt lgkmcnt(2)
    v_mfma_f32_16x16x32_bf16 v[140:143], v[124:127], v[64:67], v[140:143]
    s_waitcnt lgkmcnt(0)
    v_mfma_f32_16x16x32_bf16 v[144:147], v[128:131], v[64:67], v[144:147]
    v_add_u32 v218, 1, v218
    ds_write_b32 v217, v218
    s_add_u32 s53, s53, 2
    s_mul_i32 s58, s58, 0x9e3779b1
    s_add_u32 s58, s58, 0x7f4a7c15
    s_cmp_lg_u32 s32, 4
    s_cbranch_scc1 L_ffn
    v_lshlrev_b32 v219, 4, v2
    s_add_u32 s34, s2, 1
    s_and_b32 s34, s34, 7
    s_lshl_b32 s34, s34, 11
    s_lshl_b32 s35, s31, 8
    s_add_u32 s59, s34, s35
    s_add_u32 s59, s59, 0
    v_cvt_pk_bf16_f32 v132, v132, v133
    v_cvt_pk_bf16_f32 v134, v134, v135
    v_mov_b32 v133, s58
    v_mov_b32 v135, s58
    v_cvt_pk_bf16_f32 v136, v136, v137
    v_cvt_pk_bf16_f32 v138, v138, v139
    v_mov_b32 v137, s58
    v_mov_b32 v139, s58
    v_cvt_pk_bf16_f32 v140, v140, v141
    v_cvt_pk_bf16_f32 v142, v142, v143
    v_mov_b32 v141, s58
    v_mov_b32 v143, s58
    v_cvt_pk_bf16_f32 v144, v144, v145
    v_cvt_pk_bf16_f32 v146, v146, v147
    v_mov_b32 v145, s58
    v_mov_b32 v147, s58
    s_mov_b32 exec_lo, 0x00010001
    s_mov_b32 exec_hi, 0x00010001
    buffer_store_dwordx4 v[132:135], v219, s[36:39], s59 offen offset:0 sc1
    buffer_store_dwordx4 v[136:139], v219, s[36:39], s59 offen offset:64 sc1
    buffer_store_dwordx4 v[140:143], v219, s[36:39], s59 offen offset:128 sc1
    buffer_store_dwordx4 v[144:147], v219, s[36:39], s59 offen offset:192 sc1
    s_mov_b64 exec, -1
    s_branch L_qwait
L_ffn:
    s_mov_b32 s34, 0xbdd2d3e8
    v_mov_b32 v220, 0xc0135761
    v_cvt_pk_bf16_f32 v36, v132, v133
    v_cvt_pk_bf16_f32 v37, v134, v135
    v_cvt_pk_bf16_f32 v38, v136, v137
    v_cvt_pk_bf16_f32 v39, v138, v139
    v_cvt_pk_bf16_f32 v40, v140, v141
    v_cvt_pk_bf16_f32 v41, v142, v143
    v_cvt_pk_bf16_f32 v42, v144, v145
    v_cvt_pk_bf16_f32 v43, v146, v147
    v_and_b32 v5, 0xffff0000, v36
    v_lshlrev_b32 v4, 16, v36
    v_and_b32 v21, 0xffff0000, v208
    v_lshlrev_b32 v20, 16, v208
    v_and_b32 v7, 0xffff0000, v37
    v_lshlrev_b32 v6, 16, v37
    v_and_b32 v23, 0xffff0000, v209
    v_lshlrev_b32 v22, 16, v209
    v_and_b32 v9, 0xffff0000, v38
    v_lshlrev_b32 v8, 16, v38
    v_and_b32 v25, 0xffff0000, v210
    v_lshlrev_b32 v24, 16, v210
    v_and_b32 v11, 0xffff0000, v39
    v_lshlrev_b32 v10, 16, v39
    v_and_b32 v27, 0xffff0000, v211
    v_lshlrev_b32 v26, 16, v211
    v_and_b32 v13, 0xffff0000, v40
    v_lshlrev_b32 v12, 16, v40
    v_and_b32 v29, 0xffff0000, v212
    v_lshlrev_b32 v28, 16, v212
    v_and_b32 v15, 0xffff0000, v41
    v_lshlrev_b32 v14, 16, v41
    v_and_b32 v31, 0xffff0000, v213
    v_lshlrev_b32 v30, 16, v213
    v_and_b32 v17, 0xffff0000, v42
    v_lshlrev_b32 v16, 16, v42
    v_and_b32 v33, 0xffff0000, v214
    v_lshlrev_b32 v32, 16, v214
    v_and_b32 v19, 0xffff0000, v43
    v_lshlrev_b32 v18, 16, v43
    v_and_b32 v35, 0xffff0000, v215
    v_lshlrev_b32 v34, 16, v215
    v_add_f32 v4, v4, v20
    v_add_f32 v5, v5, v21
    v_add_f32 v6, v6, v22
    v_add_f32 v7, v7, v23
    v_add_f32 v8, v8, v24
    v_add_f32 v9, v9, v25
    v_add_f32 v10, v10, v26
    v_add_f32 v11, v11, v27
    v_add_f32 v12, v12, v28
    v_add_f32 v13, v13, v29
    v_add_f32 v14, v14, v30
    v_add_f32 v15, v15, v31
    v_add_f32 v16, v16, v32
    v_add_f32 v17, v17, v33
    v_add_f32 v18, v18, v34
    v_add_f32 v19, v19, v35
    v_cvt_pk_bf16_f32 v36, v4, v5
    v_cvt_pk_bf16_f32 v37, v6, v7
    v_cvt_pk_bf16_f32 v38, v8, v9
    v_cvt_pk_bf16_f32 v39, v10, v11
    v_cvt_pk_bf16_f32 v40, v12, v13
    v_cvt_pk_bf16_f32 v41, v14, v15
    v_cvt_pk_bf16_f32 v42, v16, v17
    v_cvt_pk_bf16_f32 v43, v18, v19
    v_and_b32 v5, 0xffff0000, v36
    v_lshlrev_b32 v4, 16, v36
    v_and_b32 v7, 0xffff0000, v37
    v_lshlrev_b32 v6, 16, v37
    v_and_b32 v9, 0xffff0000, v38
    v_lshlrev_b32 v8, 16, v38
    v_and_b32 v11, 0xffff0000, v39
    v_lshlrev_b32 v10, 16, v39
    v_and_b32 v13, 0xffff0000, v40
    v_lshlrev_b32 v12, 16, v40
    v_and_b32 v15, 0xffff0000, v41
    v_lshlrev_b32 v14, 16, v41
    v_and_b32 v17, 0xffff0000, v42
    v_lshlrev_b32 v16, 16, v42
    v_and_b32 v19, 0xffff0000, v43
    v_lshlrev_b32 v18, 16, v43
    v_mul_f32 v20, v4, v4
    v_mul_f32 v21, v5, v5
    v_mul_f32 v22, v6, v6
    v_mul_f32 v23, v7, v7
    v_mul_f32 v24, v8, v8
    v_mul_f32 v25, v9, v9
    v_mul_f32 v26, v10, v10
    v_mul_f32 v27, v11, v11
    v_mul_f32 v28, v12, v12
    v_mul_f32 v29, v13, v13
    v_mul_f32 v30, v14, v14
    v_mul_f32 v31, v15, v15
    v_mul_f32 v32, v16, v16
    v_mul_f32 v33, v17, v17
    v_mul_f32 v34, v18, v18
    v_mul_f32 v35, v19, v19
    v_fma_f32 v20, v20, s34, v220
    v_fma_f32 v21, v21, s34, v220
    v_fma_f32 v22, v22, s34, v220
    v_fma_f32 v23, v23, s34, v220
    v_fma_f32 v24, v24, s34, v220
    v_fma_f32 v25, v25, s34, v220
    v_fma_f32 v26, v26, s34, v220
    v_fma_f32 v27, v27, s34, v220
    v_fma_f32 v28, v28, s34, v220
    v_fma_f32 v29, v29, s34, v220
    v_fma_f32 v30, v30, s34, v220
    v_fma_f32 v31, v31, s34, v220
    v_fma_f32 v32, v32, s34, v220
    v_fma_f32 v33, v33, s34, v220
    v_fma_f32 v34, v34, s34, v220
    v_fma_f32 v35, v35, s34, v220
    v_mul_f32 v20, v20, v4
    v_mul_f32 v21, v21, v5
    v_mul_f32 v22, v22, v6
    v_mul_f32 v23, v23, v7
    v_mul_f32 v24, v24, v8
    v_mul_f32 v25, v25, v9
    v_mul_f32 v26, v26, v10
    v_mul_f32 v27, v27, v11
    v_mul_f32 v28, v28, v12
    v_mul_f32 v29, v29, v13
    v_mul_f32 v30, v30, v14
    v_mul_f32 v31, v31, v15
    v_mul_f32 v32, v32, v16
    v_mul_f32 v33, v33, v17
    v_mul_f32 v34, v34, v18
    v_mul_f32 v35, v35, v19
    v_exp_f32 v20, v20
    v_exp_f32 v21, v21
    v_exp_f32 v22, v22
    v_exp_f32 v23, v23
    v_exp_f32 v24, v24
    v_exp_f32 v25, v25
    v_exp_f32 v26, v26
    v_exp_f32 v27, v27
    v_exp_f32 v28, v28
    v_exp_f32 v29, v29
    v_exp_f32 v30, v30
    v_exp_f32 v31, v31
    v_exp_f32 v32, v32
    v_exp_f32 v33, v33
    v_exp_f32 v34, v34
    v_exp_f32 v35, v35
    v_add_f32 v20, 1.0, v20
    v_add_f32 v21, 1.0, v21
    v_add_f32 v22, 1.0, v22
    v_add_f32 v23, 1.0, v23
    v_add_f32 v24, 1.0, v24
    v_add_f32 v25, 1.0, v25
    v_add_f32 v26, 1.0, v26
    v_add_f32 v27, 1.0, v27
    v_add_f32 v28, 1.0, v28
    v_add_f32 v29, 1.0, v29
    v_add_f32 v30, 1.0, v30
    v_add_f32 v31, 1.0, v31
    v_add_f32 v32, 1.0, v32
    v_add_f32 v33, 1.0, v33
    v_add_f32 v34, 1.0, v34
    v_add_f32 v35, 1.0, v35
    v_rcp_f32 v20, v20
    v_rcp_f32 v21, v21
    v_rcp_f32 v22, v22
    v_rcp_f32 v23, v23
    v_rcp_f32 v24, v24
    v_rcp_f32 v25, v25
    v_rcp_f32 v26, v26
    v_rcp_f32 v27, v27
    v_rcp_f32 v28, v28
    v_rcp_f32 v29, v29
    v_rcp_f32 v30, v30
    v_rcp_f32 v31, v31
    v_rcp_f32 v32, v32
    v_rcp_f32 v33, v33
    v_rcp_f32 v34, v34
    v_rcp_f32 v35, v35
    v_mul_f32 v20, v20, v4
    v_mul_f32 v21, v21, v5
    v_mul_f32 v22, v22, v6
    v_mul_f32 v23, v23, v7
    v_mul_f32 v24, v24, v8
    v_mul_f32 v25, v25, v9
    v_mul_f32 v26, v26, v10
    v_mul_f32 v27, v27, v11
    v_mul_f32 v28, v28, v12
    v_mul_f32 v29, v29, v13
    v_mul_f32 v30, v30, v14
    v_mul_f32 v31, v31, v15
    v_mul_f32 v32, v32, v16
    v_mul_f32 v33, v33, v17
    v_mul_f32 v34, v34, v18
    v_mul_f32 v35, v35, v19
    v_cvt_pk_bf16_f32 v4, v20, v20
    v_cvt_pk_bf16_f32 v5, v21, v21
    v_cvt_pk_bf16_f32 v6, v22, v22
    v_cvt_pk_bf16_f32 v7, v23, v23
    v_cvt_pk_bf16_f32 v8, v24, v24
    v_cvt_pk_bf16_f32 v9, v25, v25
    v_cvt_pk_bf16_f32 v10, v26, v26
    v_cvt_pk_bf16_f32 v11, v27, v27
    v_cvt_pk_bf16_f32 v12, v28, v28
    v_cvt_pk_bf16_f32 v13, v29, v29
    v_cvt_pk_bf16_f32 v14, v30, v30
    v_cvt_pk_bf16_f32 v15, v31, v31
    v_cvt_pk_bf16_f32 v16, v32, v32
    v_cvt_pk_bf16_f32 v17, v33, v33
    v_cvt_pk_bf16_f32 v18, v34, v34
    v_cvt_pk_bf16_f32 v19, v35, v35
    v_mov_b32 v192, 0xffff0000
    v_cmp_eq_u32 vcc, 1, v1
    s_nop 1
    v_cndmask_b32 v188, 0, v192, vcc
    v_cmp_eq_u32 vcc, 3, v1
    s_nop 1
    v_cndmask_b32 v189, 0, v192, vcc
    v_cmp_eq_u32 vcc, 5, v1
    s_nop 1
    v_cndmask_b32 v190, 0, v192, vcc
    v_cmp_eq_u32 vcc, 7, v1
    s_nop 1
    v_cndmask_b32 v191, 0, v192, vcc
    v_mov_b32 v192, 0xffff
    v_cmp_eq_u32 vcc, 0, v1
    s_nop 1
    v_cndmask_b32 v188, v188, v192, vcc
    v_cmp_eq_u32 vcc, 2, v1
    s_nop 1
    v_cndmask_b32 v189, v189, v192, vcc
    v_cmp_eq_u32 vcc, 4, v1
    s_nop 1
    v_cndmask_b32 v190, v190, v192, vcc
    v_cmp_eq_u32 vcc, 6, v1
    s_nop 1
    v_cndmask_b32 v191, v191, v192, vcc
    v_lshlrev_b32 v196, 4, v1
    v_lshl_add_u32 v196, v2, 12, v196
    v_add_u32 v184, s54, v196
    s_add_u32 s54, s54, 16384
    s_cmp_eq_u32 s54, 149504
    s_cselect_b32 s54, 2048, s54
    v_and_b32 v36, v4, v188
    v_and_b32 v37, v4, v189
    v_and_b32 v38, v4, v190
    v_and_b32 v39, v4, v191
    v_and_b32 v40, v5, v188
    v_and_b32 v41, v5, v189
    v_and_b32 v42, v5, v190
    v_and_b32 v43, v5, v191
    v_and_b32 v44, v6, v188
    v_and_b32 v45, v6, v189
    v_and_b32 v46, v6, v190
    v_and_b32 v47, v6, v191
    v_and_b32 v48, v7, v188
    v_and_b32 v49, v7, v189
    v_and_b32 v50, v7, v190
    v_and_b32 v51, v7, v191
    s_cmp_ge_i32 s52, s53
    s_cbranch_scc1 L_ok45
L_poll46:
    ds_read_b32 v219, v216
    s_sub_u32 s33, s33, 1
    s_cbranch_scc1 L_end
    s_waitcnt lgkmcnt(0)
    v_readfirstlane_b32 s52, v219
    s_cmp_lt_i32 s52, s53
    s_cbranch_scc1 L_poll46
L_ok45:
    ds_read_b128 v[68:71], v184 offset:0
    ds_read_b128 v[72:75], v184 offset:256
    ds_read_b128 v[76:79], v184 offset:512
    ds_read_b128 v[80:83], v184 offset:768
    ds_read_b128 v[84:87], v184 offset:1024
    ds_read_b128 v[88:91], v184 offset:1280
    ds_read_b128 v[92:95], v184 offset:1536
    s_waitcnt lgkmcnt(6)
    v_mfma_f32_16x16x32_bf16 v[148:151], v[36:39], v[68:71], 0
    ds_read_b128 v[96:99], v184 offset:1792
    s_waitcnt lgkmcnt(6)
    v_mfma_f32_16x16x32_bf16 v[152:155], v[36:39], v[72:75], 0
    ds_read_b128 v[100:103], v184 offset:2048
    s_waitcnt lgkmcnt(6)
    v_mfma_f32_16x16x32_bf16 v[156:159], v[36:39], v[76:79], 0
    ds_read_b128 v[104:107], v184 offset:2304
    s_waitcnt lgkmcnt(6)
    v_mfma_f32_16x16x32_bf16 v[160:163], v[36:39], v[80:83], 0
    ds_read_b128 v[108:111], v184 offset:2560
    s_waitcnt lgkmcnt(6)
    v_mfma_f32_16x16x32_bf16 v[148:151], v[40:43], v[84:87], v[148:151]
    ds_read_b128 v[112:115], v184 offset:2816
    s_waitcnt lgkmcnt(6)
    v_mfma_f32_16x16x32_bf16 v[152:155], v[40:43], v[88:91], v[152:155]
    ds_read_b128 v[116:119], v184 offset:3072
    s_waitcnt lgkmcnt(6)
    v_mfma_f32_16x16x32_bf16 v[156:159], v[40:43], v[92:95], v[156:159]
    ds_read_b128 v[120:123], v184 offset:3328
    s_waitcnt lgkmcnt(6)
    v_mfma_f32_16x16x32_bf16 v[160:163], v[40:43], v[96:99], v[160:163]
    ds_read_b128 v[124:127], v184 offset:3584
    s_waitcnt lgkmcnt(6)
    v_mfma_f32_16x16x32_bf16 v[148:151], v[44:47], v[100:103], v[148:151]
    ds_read_b128 v[128:131], v184 offset:3840
    s_waitcnt lgkmcnt(6)
    v_mfma_f32_16x16x32_bf16 v[152:155], v[44:47], v[104:107], v[152:155]
    s_waitcnt lgkmcnt(5)
    v_mfma_f32_16x16x32_bf16 v[156:159], v[44:47], v[108:111], v[156:159]
    s_waitcnt lgkmcnt(4)
    v_mfma_f32_16x16x32_bf16 v[160:163], v[44:47], v[112:115], v[160:163]
    s_waitcnt lgkmcnt(3)
    v_mfma_f32_16x16x32_bf16 v[148:151], v[48:51], v[116:119], v[148:151]
    s_waitcnt lgkmcnt(2)
    v_mfma_f32_16x16x32_bf16 v[152:155], v[48:51], v[120:123], v[152:155]
    s_waitcnt lgkmcnt(1)
    v_mfma_f32_16x16x32_bf16 v[156:159], v[48:51], v[124:127], v[156:159]
    s_waitcnt lgkmcnt(0)
    v_mfma_f32_16x16x32_bf16 v[160:163], v[48:51], v[128:131], v[160:163]
    v_add_u32 v218, 1, v218
    ds_write_b32 v217, v218
    s_add_u32 s53, s53, 2
    v_add_u32 v184, s54, v196
    s_add_u32 s54, s54, 16384
    s_cmp_eq_u32 s54, 149504
    s_cselect_b32 s54, 2048, s54
    v_and_b32 v36, v8, v188
    v_and_b32 v37, v8, v189
    v_and_b32 v38, v8, v190
    v_and_b32 v39, v8, v191
    v_and_b32 v40, v9, v188
    v_and_b32 v41, v9, v189
    v_and_b32 v42, v9, v190
    v_and_b32 v43, v9, v191
    v_and_b32 v44, v10, v188
    v_and_b32 v45, v10, v189
    v_and_b32 v46, v10, v190
    v_and_b32 v47, v10, v191
    v_and_b32 v48, v11, v188
    v_and_b32 v49, v11, v189
    v_and_b32 v50, v11, v190
    v_and_b32 v51, v11, v191
    s_cmp_ge_i32 s52, s53
    s_cbranch_scc1 L_ok47
L_poll48:
    ds_read_b32 v219, v216
    s_sub_u32 s33, s33, 1
    s_cbranch_scc1 L_end
    s_waitcnt lgkmcnt(0)
    v_readfirstlane_b32 s52, v219
    s_cmp_lt_i32 s52, s53
    s_cbranch_scc1 L_poll48
L_ok47:
    ds_read_b128 v[68:71], v184 offset:0
    ds_read_b128 v[72:75], v184 offset:256
    ds_read_b128 v[76:79], v184 offset:512
    ds_read_b128 v[80:83], v184 offset:768
    ds_read_b128 v[84:87], v184 offset:1024
    ds_read_b128 v[88:91], v184 offset:1280
    ds_read_b128 v[92:95], v184 offset:1536
    s_waitcnt lgkmcnt(6)
    v_mfma_f32_16x16x32_bf16 v[148:151], v[36:39], v[68:71], v[148:151]
    ds_read_b128 v[96:99], v184 offset:1792
    s_waitcnt lgkmcnt(6)
    v_mfma_f32_16x16x32_bf16 v[152:155], v[36:39], v[72:75], v[152:155]
    ds_read_b128 v[100:103], v184 offset:2048
    s_waitcnt lgkmcnt(6)
    v_mfma_f32_16x16x32_bf16 v[156:159], v[36:39], v[76:79], v[156:159]
    ds_read_b128 v[104:107], v184 offset:2304
    s_waitcnt lgkmcnt(6)
    v_mfma_f32_16x16x32_bf16 v[160:163], v[36:39], v[80:83], v[160:163]
    ds_read_b128 v[108:111], v184 offset:2560
    s_waitcnt lgkmcnt(6)
    v_mfma_f32_16x16x32_bf16 v[148:151], v[40:43], v[84:87], v[148:151]
    ds_read_b128 v[112:115], v184 offset:2816
    s_waitcnt lgkmcnt(6)
    v_mfma_f32_16x16x32_bf16 v[152:155], v[40:43], v[88:91], v[152:155]
    ds_read_b128 v[116:119], v184 offset:3072
    s_waitcnt lgkmcnt(6)
    v_mfma_f32_16x16x32_bf16 v[156:159], v[40:43], v[92:95], v[156:159]
    ds_read_b128 v[120:123], v184 offset:3328
    s_waitcnt lgkmcnt(6)
    v_mfma_f32_16x16x32_bf16 v[160:163], v[40:43], v[96:99], v[160:163]
    ds_read_b128 v[124:127], v184 offset:3584
    s_waitcnt lgkmcnt(6)
    v_mfma_f32_16x16x32_bf16 v[148:151], v[44:47], v[100:103], v[148:151]
    ds_read_b128 v[128:131], v184 offset:3840
    s_waitcnt lgkmcnt(6)
    v_mfma_f32_16x16x32_bf16 v[152:155], v[44:47], v[104:107], v[152:155]
    s_waitcnt lgkmcnt(5)
    v_mfma_f32_16x16x32_bf16 v[156:159], v[44:47], v[108:111], v[156:159]
    s_waitcnt lgkmcnt(4)
    v_mfma_f32_16x16x32_bf16 v[160:163], v[44:47], v[112:115], v[160:163]
    s_waitcnt lgkmcnt(3)
    v_mfma_f32_16x16x32_bf16 v[148:151], v[48:51], v[116:119], v[148:151]
    s_waitcnt lgkmcnt(2)
    v_mfma_f32_16x16x32_bf16 v[152:155], v[48:51], v[120:123], v[152:155]
    s_waitcnt lgkmcnt(1)
    v_mfma_f32_16x16x32_bf16 v[156:159], v[48:51], v[124:127], v[156:159]
    s_waitcnt lgkmcnt(0)
    v_mfma_f32_16x16x32_bf16 v[160:163], v[48:51], v[128:131], v[160:163]
    v_add_u32 v218, 1, v218
    ds_write_b32 v217, v218
    s_add_u32 s53, s53, 2
    v_add_u32 v184, s54, v196
    s_add_u32 s54, s54, 16384
    s_cmp_eq_u32 s54, 149504
    s_cselect_b32 s54, 2048, s54
    v_and_b32 v36, v12, v188
    v_and_b32 v37, v12, v189
    v_and_b32 v38, v12, v190
    v_and_b32 v39, v12, v191
    v_and_b32 v40, v13, v188
    v_and_b32 v41, v13, v189
    v_and_b32 v42, v13, v190
    v_and_b32 v43, v13, v191
    v_and_b32 v44, v14, v188
    v_and_b32 v45, v14, v189
    v_and_b32 v46, v14, v190
    v_and_b32 v47, v14, v191
    v_and_b32 v48, v15, v188
    v_and_b32 v49, v15, v189
    v_and_b32 v50, v15, v190
    v_and_b32 v51, v15, v191
    s_cmp_ge_i32 s52, s53
    s_cbranch_scc1 L_ok49
L_poll50:
    ds_read_b32 v219, v216
    s_sub_u32 s33, s33, 1
    s_cbranch_scc1 L_end
    s_waitcnt lgkmcnt(0)
    v_readfirstlane_b32 s52, v219
    s_cmp_lt_i32 s52, s53
    s_cbranch_scc1 L_poll50
L_ok49:
    ds_read_b128 v[68:71], v184 offset:0
    ds_read_b128 v[72:75], v184 offset:256
    ds_read_b128 v[76:79], v184 offset:512
    ds_read_b128 v[80:83], v184 offset:768
    ds_read_b128 v[84:87], v184 offset:1024
    ds_read_b128 v[88:91], v184 offset:1280
    ds_read_b128 v[92:95], v184 offset:1536
    s_waitcnt lgkmcnt(6)
    v_mfma_f32_16x16x32_bf16 v[148:151], v[36:39], v[68:71], v[148:151]
    ds_read_b128 v[96:99], v184 offset:1792
    s_waitcnt lgkmcnt(6)
    v_mfma_f32_16x16x32_bf16 v[152:155], v[36:39], v[72:75], v[152:155]
    ds_read_b128 v[100:103], v184 offset:2048
    s_waitcnt lgkmcnt(6)
    v_mfma_f32_16x16x32_bf16 v[156:159], v[36:39], v[76:79], v[156:159]
    ds_read_b128 v[104:107], v184 offset:2304
    s_waitcnt lgkmcnt(6)
    v_mfma_f32_16x16x32_bf16 v[160:163], v[36:39], v[80:83], v[160:163]
    ds_read_b128 v[108:111], v184 offset:2560
    s_waitcnt lgkmcnt(6)
    v_mfma_f32_16x16x32_bf16 v[148:151], v[40:43], v[84:87], v[148:151]
    ds_read_b128 v[112:115], v184 offset:2816
    s_waitcnt lgkmcnt(6)
    v_mfma_f32_16x16x32_bf16 v[152:155], v[40:43], v[88:91], v[152:155]
    ds_read_b128 v[116:119], v184 offset:3072
    s_waitcnt lgkmcnt(6)
    v_mfma_f32_16x16x32_bf16 v[156:159], v[40:43], v[92:95], v[156:159]
    ds_read_b128 v[120:123], v184 offset:3328
    s_waitcnt lgkmcnt(6)
    v_mfma_f32_16x16x32_bf16 v[160:163], v[40:43], v[96:99], v[160:163]
    ds_read_b128 v[124:127], v184 offset:3584
    s_waitcnt lgkmcnt(6)
    v_mfma_f32_16x16x32_bf16 v[148:151], v[44:47], v[100:103], v[148:151]
    ds_read_b128 v[128:131], v184 offset:3840
    s_waitcnt lgkmcnt(6)
    v_mfma_f32_16x16x32_bf16 v[152:155], v[44:47], v[104:107], v[152:155]
    s_waitcnt lgkmcnt(5)
    v_mfma_f32_16x16x32_bf16 v[156:159], v[44:47], v[108:111], v[156:159]
    s_waitcnt lgkmcnt(4)
    v_mfma_f32_16x16x32_bf16 v[160:163], v[44:47], v[112:115], v[160:163]
    s_waitcnt lgkmcnt(3)
    v_mfma_f32_16x16x32_bf16 v[148:151], v[48:51], v[116:119], v[148:151]
    s_waitcnt lgkmcnt(2)
    v_mfma_f32_16x16x32_bf16 v[152:155], v[48:51], v[120:123], v[152:155]
    s_waitcnt lgkmcnt(1)
    v_mfma_f32_16x16x32_bf16 v[156:159], v[48:51], v[124:127], v[156:159]
    s_waitcnt lgkmcnt(0)
    v_mfma_f32_16x16x32_bf16 v[160:163], v[48:51], v[128:131], v[160:163]
    v_add_u32 v218, 1, v218
    ds_write_b32 v217, v218
    s_add_u32 s53, s53, 2
    v_add_u32 v184, s54, v196
    s_add_u32 s54, s54, 16384
    s_cmp_eq_u32 s54, 149504
    s_cselect_b32 s54, 2048, s54
    v_and_b32 v36, v16, v188
    v_and_b32 v37, v16, v189
    v_and_b32 v38, v16, v190
    v_and_b32 v39, v16, v191
    v_and_b32 v40, v17, v188
    v_and_b32 v41, v17, v189
    v_and_b32 v42, v17, v190
    v_and_b32 v43, v17, v191
    v_and_b32 v44, v18, v188
    v_and_b32 v45, v18, v189
    v_and_b32 v46, v18, v190
    v_and_b32 v47, v18, v191
    v_and_b32 v48, v19, v188
    v_and_b32 v49, v19, v189
    v_and_b32 v50, v19, v190
    v_and_b32 v51, v19, v191
    s_cmp_ge_i32 s52, s53
    s_cbranch_scc1 L_ok51
L_poll52:
    ds_read_b32 v219, v216
    s_sub_u32 s33, s33, 1
    s_cbranch_scc1 L_end
    s_waitcnt lgkmcnt(0)
    v_readfirstlane_b32 s52, v219
    s_cmp_lt_i32 s52, s53
    s_cbranch_scc1 L_poll52
L_ok51:
    ds_read_b128 v[68:71], v184 offset:0
    ds_read_b128 v[72:75], v184 offset:256
    ds_read_b128 v[76:79], v184 offset:512
    ds_read_b128 v[80:83], v184 offset:768
    ds_read_b128 v[84:87], v184 offset:1024
    ds_read_b128 v[88:91], v184 offset:1280
    ds_read_b128 v[92:95], v184 offset:1536
    s_waitcnt lgkmcnt(6)
    v_mfma_f32_16x16x32_bf16 v[148:151], v[36:39], v[68:71], v[148:151]
    ds_read_b128 v[96:99], v184 offset:1792
    s_waitcnt lgkmcnt(6)
    v_mfma_f32_16x16x32_bf16 v[152:155], v[36:39], v[72:75], v[152:155]
    ds_read_b128 v[100:103], v184 offset:2048
    s_waitcnt lgkmcnt(6)
    v_mfma_f32_16x16x32_bf16 v[156:159], v[36:39], v[76:79], v[156:159]
    ds_read_b128 v[104:107], v184 offset:2304
    s_waitcnt lgkmcnt(6)
    v_mfma_f32_16x16x32_bf16 v[160:163], v[36:39], v[80:83], v[160:163]
    ds_read_b128 v[108:111], v184 offset:2560
    s_waitcnt lgkmcnt(6)
    v_mfma_f32_16x16x32_bf16 v[148:151], v[40:43], v[84:87], v[148:151]
    ds_read_b128 v[112:115], v184 offset:2816
    s_waitcnt lgkmcnt(6)
    v_mfma_f32_16x16x32_bf16 v[152:155], v[40:43], v[88:91], v[152:155]
    ds_read_b128 v[116:119], v184 offset:3072
    s_waitcnt lgkmcnt(6)
    v_mfma_f32_16x16x32_bf16 v[156:159], v[40:43], v[92:95], v[156:159]
    ds_read_b128 v[120:123], v184 offset:3328
    s_waitcnt lgkmcnt(6)
    v_mfma_f32_16x16x32_bf16 v[160:163], v[40:43], v[96:99], v[160:163]
    ds_read_b128 v[124:127], v184 offset:3584
    s_waitcnt lgkmcnt(6)
    v_mfma_f32_16x16x32_bf16 v[148:151], v[44:47], v[100:103], v[148:151]
    ds_read_b128 v[128:131], v184 offset:3840
    s_waitcnt lgkmcnt(6)
    v_mfma_f32_16x16x32_bf16 v[152:155], v[44:47], v[104:107], v[152:155]
    s_waitcnt lgkmcnt(5)
    v_mfma_f32_16x16x32_bf16 v[156:159], v[44:47], v[108:111], v[156:159]
    s_waitcnt lgkmcnt(4)
    v_mfma_f32_16x16x32_bf16 v[160:163], v[44:47], v[112:115], v[160:163]
    s_waitcnt lgkmcnt(3)
    v_mfma_f32_16x16x32_bf16 v[148:151], v[48:51], v[116:119], v[148:151]
    s_waitcnt lgkmcnt(2)
    v_mfma_f32_16x16x32_bf16 v[152:155], v[48:51], v[120:123], v[152:155]
    s_waitcnt lgkmcnt(1)
    v_mfma_f32_16x16x32_bf16 v[156:159], v[48:51], v[124:127], v[156:159]
    s_waitcnt lgkmcnt(0)
    v_mfma_f32_16x16x32_bf16 v[160:163], v[48:51], v[128:131], v[160:163]
    v_add_u32 v218, 1, v218
    ds_write_b32 v217, v218
    s_add_u32 s53, s53, 2
    s_bfe_u32 s34, s58, 0xa0000
    v_mov_b32 v180, s34
    s_bfe_u32 s34, s58, 0xa0008
    v_mov_b32 v181, s34
    s_bfe_u32 s34, s58, 0xa0010
    v_mov_b32 v182, s34
    s_bfe_u32 s34, s58, 0xa0016
    v_mov_b32 v183, s34
    v_lshl_add_u32 v220, v1, 1, v2
    v_lshrrev_b32 v219, 1, v220
    v_mul_u32_u24 v219, 1024, v219
    v_and_b32 v184, 1, v220
    v_lshlrev_b32 v184, 4, v184
    v_add_u32 v184, v184, v219
    s_mul_i32 s34, s15, 32
    s_add_u32 s34, s34, 2097152
    v_add_u32 v184, s34, v184
    v_and_or_b32 v148, v148, s44, v180
    v_and_or_b32 v149, v149, s44, v181
    v_and_or_b32 v150, v150, s44, v182
    v_and_or_b32 v151, v151, s44, v183
    v_and_or_b32 v152, v152, s44, v180
    v_and_or_b32 v153, v153, s44, v181
    v_and_or_b32 v154, v154, s44, v182
    v_and_or_b32 v155, v155, s44, v183
    v_and_or_b32 v156, v156, s44, v180
    v_and_or_b32 v157, v157, s44, v181
    v_and_or_b32 v158, v158, s44, v182
    v_and_or_b32 v159, v159, s44, v183
    v_and_or_b32 v160, v160, s44, v180
    v_and_or_b32 v161, v161, s44, v181
    v_and_or_b32 v162, v162, s44, v182
    v_and_or_b32 v163, v163, s44, v183
    s_mov_b32 exec_hi, 0
    s_mov_b32 s34, 0
    buffer_store_dwordx4 v[148:151], v184, s[36:39], s34 offen sc1
    s_mov_b32 s34, 16384
    buffer_store_dwordx4 v[152:155], v184, s[36:39], s34 offen sc1
    s_mov_b32 s34, 32768
    buffer_store_dwordx4 v[156:159], v184, s[36:39], s34 offen sc1
    s_mov_b32 s34, 49152
    buffer_store_dwordx4 v[160:163], v184, s[36:39], s34 offen sc1
    s_mov_b32 exec_hi, -1
    s_branch L_qwait
L_qw0:
    s_waitcnt lgkmcnt(0)
    s_mul_i32 s58, s58, 0x9e3779b1
    s_add_u32 s58, s58, 0x7f4a7c15
L_qwait:
    v_mov_b32 v4, 0
    v_mov_b32 v5, 0
    v_mov_b32 v6, 0
    v_mov_b32 v7, 0
    v_mov_b32 v8, 0
    v_mov_b32 v9, 0
    v_mov_b32 v10, 0
    v_mov_b32 v11, 0
    v_mov_b32 v12, 0
    v_mov_b32 v13, 0
    v_mov_b32 v14, 0
    v_mov_b32 v15, 0
    v_mov_b32 v16, 0
    v_mov_b32 v17, 0
    v_mov_b32 v18, 0
    v_mov_b32 v19, 0
    v_mov_b32 v20, 0
    v_mov_b32 v21, 0
    v_mov_b32 v22, 0
    v_mov_b32 v23, 0
    v_mov_b32 v24, 0
    v_mov_b32 v25, 0
    v_mov_b32 v26, 0
    v_mov_b32 v27, 0
    v_mov_b32 v28, 0
    v_mov_b32 v29, 0
    v_mov_b32 v30, 0
    v_mov_b32 v31, 0
    v_mov_b32 v32, 0
    v_mov_b32 v33, 0
    v_mov_b32 v34, 0
    v_mov_b32 v35, 0
    v_mov_b32 v36, 0
    v_mov_b32 v37, 0
    v_mov_b32 v38, 0
    v_mov_b32 v39, 0
    v_mov_b32 v40, 0
    v_mov_b32 v41, 0
    v_mov_b32 v42, 0
    v_mov_b32 v43, 0
    v_mov_b32 v44, 0
    v_mov_b32 v45, 0
    v_mov_b32 v46, 0
    v_mov_b32 v47, 0
    v_mov_b32 v48, 0
    v_mov_b32 v49, 0
    v_mov_b32 v50, 0
    v_mov_b32 v51, 0
    v_mov_b32 v52, 0
    v_mov_b32 v53, 0
    v_mov_b32 v54, 0
    v_mov_b32 v55, 0
    v_mov_b32 v56, 0
    v_mov_b32 v57, 0
    v_mov_b32 v58, 0
    v_mov_b32 v59, 0
    v_mov_b32 v60, 0
    v_mov_b32 v61, 0
    v_mov_b32 v62, 0
    v_mov_b32 v63, 0
    v_mov_b32 v64, 0
    v_mov_b32 v65, 0
    v_mov_b32 v66, 0
    v_mov_b32 v67, 0
    v_mov_b32 v132, 0
    v_mov_b32 v133, 0
    v_mov_b32 v134, 0
    v_mov_b32 v135, 0
    v_mov_b32 v136, 0
    v_mov_b32 v137, 0
    v_mov_b32 v138, 0
    v_mov_b32 v139, 0
    v_mov_b32 v140, 0
    v_mov_b32 v141, 0
    v_mov_b32 v142, 0
    v_mov_b32 v143, 0
    v_mov_b32 v144, 0
    v_mov_b32 v145, 0
    v_mov_b32 v146, 0
    v_mov_b32 v147, 0
    v_mov_b32 v148, 0
    v_mov_b32 v149, 0
    v_mov_b32 v150, 0
    v_mov_b32 v151, 0
    v_mov_b32 v152, 0
    v_mov_b32 v153, 0
    v_mov_b32 v154, 0
    v_mov_b32 v155, 0
    v_mov_b32 v156, 0
    v_mov_b32 v157, 0
    v_mov_b32 v158, 0
    v_mov_b32 v159, 0
    v_mov_b32 v160, 0
    v_mov_b32 v161, 0
    v_mov_b32 v162, 0
    v_mov_b32 v163, 0
    s_lshl_b32 s34, s30, 16
    s_lshl_b32 s35, s31, 6
    s_add_u32 s60, s34, s35
    s_add_u32 s60, s60, 65536
    s_add_u32 s61, s60, 4096
    s_add_u32 s62, s60, 8192
    s_add_u32 s63, s60, 12288
    s_lshl_b32 s34, s30, 11
    s_lshl_b32 s35, s31, 4
    s_add_u32 s34, s34, s35
    s_add_u32 s34, s34, 16384
    v_lshlrev_b32 v227, 9, v0
    v_add_u32 v227, s34, v227
    v_lshlrev_b32 v226, 14, v1
    v_lshl_add_u32 v226, v2, 4, v226
    v_add_u32 v220, 0, v2
    v_xor_b32 v220, v220, v1
    v_lshlrev_b32 v220, 4, v220
    v_lshl_add_u32 v196, v1, 8, v220
    v_add_u32 v220, 4, v2
    v_xor_b32 v220, v220, v1
    v_lshlrev_b32 v220, 4, v220
    v_lshl_add_u32 v197, v1, 8, v220
    v_add_u32 v220, 8, v2
    v_xor_b32 v220, v220, v1
    v_lshlrev_b32 v220, 4, v220
    v_lshl_add_u32 v198, v1, 8, v220
    v_add_u32 v220, 12, v2
    v_xor_b32 v220, v220, v1
    v_lshlrev_b32 v220, 4, v220
    v_lshl_add_u32 v199, v1, 8, v220
    v_lshrrev_b32 v188, 2, v0
    v_and_b32 v189, 7, v188
    v_and_b32 v190, 3, v0
    v_lshlrev_b32 v190, 3, v190
    v_lshl_add_u32 v190, v188, 8, v190
    v_xor_b32 v220, 0, v189
    v_lshl_add_u32 v200, v220, 5, v190
    v_xor_b32 v220, 1, v189
    v_lshl_add_u32 v201, v220, 5, v190
    v_xor_b32 v220, 2, v189
    v_lshl_add_u32 v202, v220, 5, v190
    v_xor_b32 v220, 3, v189
    v_lshl_add_u32 v203, v220, 5, v190
    v_xor_b32 v220, 4, v189
    v_lshl_add_u32 v204, v220, 5, v190
    v_xor_b32 v220, 5, v189
    v_lshl_add_u32 v205, v220, 5, v190
    v_xor_b32 v220, 6, v189
    v_lshl_add_u32 v206, v220, 5, v190
    v_xor_b32 v220, 7, v189
    v_lshl_add_u32 v207, v220, 5, v190
    v_and_b32 v184, 3, v0
    v_lshlrev_b32 v184, 9, v184
    v_lshrrev_b32 v219, 2, v1
    v_lshl_add_u32 v184, v219, 7, v184
    v_lshl_add_u32 v184, v2, 5, v184
    v_mov_b32 v221, 0xfe967699
    v_mov_b32 v176, 0xfe967699
    v_mov_b32 v178, 0
    s_mov_b32 s55, 1
    s_mov_b32 s56, 0x3db504f3
    s_mov_b32 s57, 0x3fb8aa3b
    s_bfe_u32 s34, s58, 0xa0000
    v_mov_b32 v180, s34
    s_bfe_u32 s34, s58, 0xa0008
    v_mov_b32 v181, s34
    s_bfe_u32 s34, s58, 0xa0010
    v_mov_b32 v182, s34
    s_bfe_u32 s34, s58, 0xa0016
    v_mov_b32 v183, s34
    v_mov_b32 v177, s58
    v_mov_b32 v179, s58
    s_cmp_eq_u32 s32, 0
    s_cselect_b32 s35, 9, 13
    s_cmp_ge_i32 s52, s35
    s_cbranch_scc1 L_ok53
L_poll54:
    ds_read_b32 v219, v216
    s_sub_u32 s33, s33, 1
    s_cbranch_scc1 L_end
    s_sleep 1
    s_waitcnt lgkmcnt(0)
    v_readfirstlane_b32 s52, v219
    s_cmp_lt_i32 s52, s35
    s_cbranch_scc1 L_poll54
L_ok53:
    s_lshl_b32 s59, s30, 11
    s_add_u32 s59, s59, 0
L_qpoll:
    s_sub_u32 s33, s33, 1
    s_cbranch_scc1 L_end
    buffer_load_dwordx4 v[68:71], v184, s[36:39], s59 offen offset:0 sc1
    buffer_load_dwordx4 v[72:75], v184, s[36:39], s59 offen offset:16 sc1
    s_waitcnt vmcnt(0)
    v_xor_b32 v69, s58, v69
    v_xor_b32 v71, s58, v71
    v_xor_b32 v73, s58, v73
    v_xor_b32 v75, s58, v75
    v_or3_b32 v219, v69, v71, v73
    v_or_b32 v219, v219, v75
    v_cmp_ne_u32 vcc, 0, v219
    s_mov_b64 exec, vcc
    s_cbranch_execnz L_qpoll
    s_mov_b64 exec, -1
    v_mov_b32_dpp v4, v68 quad_perm:[0,1,2,3] row_mask:0xf bank_mask:0x1
    v_mov_b32_dpp v5, v70 quad_perm:[0,1,2,3] row_mask:0xf bank_mask:0x1
    v_mov_b32_dpp v6, v72 quad_perm:[0,1,2,3] row_mask:0xf bank_mask:0x1
    v_mov_b32_dpp v7, v74 quad_perm:[0,1,2,3] row_mask:0xf bank_mask:0x1
    v_mov_b32_dpp v8, v68 row_ror:12 row_mask:0xf bank_mask:0x1
    v_mov_b32_dpp v9, v70 row_ror:12 row_mask:0xf bank_mask:0x1
    v_mov_b32_dpp v10, v72 row_ror:12 row_mask:0xf bank_mask:0x1
    v_mov_b32_dpp v11, v74 row_ror:12 row_mask:0xf bank_mask:0x1
    v_mov_b32_dpp v12, v68 row_ror:8 row_mask:0xf bank_mask:0x1
    v_mov_b32_dpp v13, v70 row_ror:8 row_mask:0xf bank_mask:0x1
    v_mov_b32_dpp v14, v72 row_ror:8 row_mask:0xf bank_mask:0x1
    v_mov_b32_dpp v15, v74 row_ror:8 row_mask:0xf bank_mask:0x1
    v_mov_b32_dpp v16, v68 row_ror:4 row_mask:0xf bank_mask:0x1
    v_mov_b32_dpp v17, v70 row_ror:4 row_mask:0xf bank_mask:0x1
    v_mov_b32_dpp v18, v72 row_ror:4 row_mask:0xf bank_mask:0x1
    v_mov_b32_dpp v19, v74 row_ror:4 row_mask:0xf bank_mask:0x1
    v_mov_b32_dpp v20, v68 row_ror:4 row_mask:0xf bank_mask:0x2
    v_mov_b32_dpp v21, v70 row_ror:4 row_mask:0xf bank_mask:0x2
    v_mov_b32_dpp v22, v72 row_ror:4 row_mask:0xf bank_mask:0x2
    v_mov_b32_dpp v23, v74 row_ror:4 row_mask:0xf bank_mask:0x2
    v_mov_b32_dpp v24, v68 quad_perm:[0,1,2,3] row_mask:0xf bank_mask:0x2
    v_mov_b32_dpp v25, v70 quad_perm:[0,1,2,3] row_mask:0xf bank_mask:0x2
    v_mov_b32_dpp v26, v72 quad_perm:[0,1,2,3] row_mask:0xf bank_mask:0x2
    v_mov_b32_dpp v27, v74 quad_perm:[0,1,2,3] row_mask:0xf bank_mask:0x2
    v_mov_b32_dpp v28, v68 row_ror:12 row_mask:0xf bank_mask:0x2
    v_mov_b32_dpp v29, v70 row_ror:12 row_mask:0xf bank_mask:0x2
    v_mov_b32_dpp v30, v72 row_ror:12 row_mask:0xf bank_mask:0x2
    v_mov_b32_dpp v31, v74 row_ror:12 row_mask:0xf bank_mask:0x2
    v_mov_b32_dpp v32, v68 row_ror:8 row_mask:0xf bank_mask:0x2
    v_mov_b32_dpp v33, v70 row_ror:8 row_mask:0xf bank_mask:0x2
    v_mov_b32_dpp v34, v72 row_ror:8 row_mask:0xf bank_mask:0x2
    v_mov_b32_dpp v35, v74 row_ror:8 row_mask:0xf bank_mask:0x2
    v_mov_b32_dpp v36, v68 row_ror:8 row_mask:0xf bank_mask:0x4
    v_mov_b32_dpp v37, v70 row_ror:8 row_mask:0xf bank_mask:0x4
    v_mov_b32_dpp v38, v72 row_ror:8 row_mask:0xf bank_mask:0x4
    v_mov_b32_dpp v39, v74 row_ror:8 row_mask:0xf bank_mask:0x4
    v_mov_b32_dpp v40, v68 row_ror:4 row_mask:0xf bank_mask:0x4
    v_mov_b32_dpp v41, v70 row_ror:4 row_mask:0xf bank_mask:0x4
    v_mov_b32_dpp v42, v72 row_ror:4 row_mask:0xf bank_mask:0x4
    v_mov_b32_dpp v43, v74 row_ror:4 row_mask:0xf bank_mask:0x4
    v_mov_b32_dpp v44, v68 quad_perm:[0,1,2,3] row_mask:0xf bank_mask:0x4
    v_mov_b32_dpp v45, v70 quad_perm:[0,1,2,3] row_mask:0xf bank_mask:0x4
    v_mov_b32_dpp v46, v72 quad_perm:[0,1,2,3] row_mask:0xf bank_mask:0x4
    v_mov_b32_dpp v47, v74 quad_perm:[0,1,2,3] row_mask:0xf bank_mask:0x4
    v_mov_b32_dpp v48, v68 row_ror:12 row_mask:0xf bank_mask:0x4
    v_mov_b32_dpp v49, v70 row_ror:12 row_mask:0xf bank_mask:0x4
    v_mov_b32_dpp v50, v72 row_ror:12 row_mask:0xf bank_mask:0x4
    v_mov_b32_dpp v51, v74 row_ror:12 row_mask:0xf bank_mask:0x4
    v_mov_b32_dpp v52, v68 row_ror:12 row_mask:0xf bank_mask:0x8
    v_mov_b32_dpp v53, v70 row_ror:12 row_mask:0xf bank_mask:0x8
    v_mov_b32_dpp v54, v72 row_ror:12 row_mask:0xf bank_mask:0x8
    v_mov_b32_dpp v55, v74 row_ror:12 row_mask:0xf bank_mask:0x8
    v_mov_b32_dpp v56, v68 row_ror:8 row_mask:0xf bank_mask:0x8
    v_mov_b32_dpp v57, v70 row_ror:8 row_mask:0xf bank_mask:0x8
    v_mov_b32_dpp v58, v72 row_ror:8 row_mask:0xf bank_mask:0x8
    v_mov_b32_dpp v59, v74 row_ror:8 row_mask:0xf bank_mask:0x8
    v_mov_b32_dpp v60, v68 row_ror:4 row_mask:0xf bank_mask:0x8
    v_mov_b32_dpp v61, v70 row_ror:4 row_mask:0xf bank_mask:0x8
    v_mov_b32_dpp v62, v72 row_ror:4 row_mask:0xf bank_mask:0x8
    v_mov_b32_dpp v63, v74 row_ror:4 row_mask:0xf bank_mask:0x8
    v_mov_b32_dpp v64, v68 quad_perm:[0,1,2,3] row_mask:0xf bank_mask:0x8
    v_mov_b32_dpp v65, v70 quad_perm:[0,1,2,3] row_mask:0xf bank_mask:0x8
    v_mov_b32_dpp v66, v72 quad_perm:[0,1,2,3] row_mask:0xf bank_mask:0x8
    v_mov_b32_dpp v67, v74 quad_perm:[0,1,2,3] row_mask:0xf bank_mask:0x8
L_loop:
    v_add_u32 v184, s54, v196
    v_add_u32 v185, s54, v197
    v_add_u32 v186, s54, v198
    v_add_u32 v187, s54, v199
    s_add_u32 s54, s54, 16384
    s_cmp_eq_u32 s54, 149504
    s_cselect_b32 s54, 2048, s54
    v_add_u32 v188, s54, v200
    v_add_u32 v189, s54, v201
    v_add_u32 v190, s54, v202
    v_add_u32 v191, s54, v203
    v_add_u32 v192, s54, v204
    v_add_u32 v193, s54, v205
    v_add_u32 v194, s54, v206
    v_add_u32 v195, s54, v207
    s_add_u32 s54, s54, 16384
    s_cmp_eq_u32 s54, 149504
    s_cselect_b32 s54, 2048, s54
    s_cmp_ge_i32 s52, s53
    s_cbranch_scc1 L_ok55
L_poll56:
    ds_read_b32 v219, v216
    s_sub_u32 s33, s33, 1
    s_cbranch_scc1 L_end
    s_waitcnt lgkmcnt(0)
    v_readfirstlane_b32 s52, v219
    s_cmp_lt_i32 s52, s53
    s_cbranch_scc1 L_poll56
L_ok55:
    ds_read_b128 v[68:71], v184 offset:0
    ds_read_b128 v[72:75], v185 offset:0
    ds_read_b128 v[76:79], v186 offset:0
    ds_read_b128 v[80:83], v187 offset:0
    ds_read_b128 v[84:87], v184 offset:4096
    ds_read_b128 v[88:91], v185 offset:4096
    ds_read_b128 v[92:95], v186 offset:4096
    s_waitcnt lgkmcnt(6)
    v_mfma_f32_16x16x32_bf16 v[164:167], v[68:71], v[4:7], 0
    ds_read_b128 v[96:99], v187 offset:4096
    s_waitcnt lgkmcnt(6)
    v_mfma_f32_16x16x32_bf16 v[164:167], v[72:75], v[8:11], v[164:167]
    ds_read_b128 v[100:103], v184 offset:8192
    s_waitcnt lgkmcnt(6)
    v_mfma_f32_16x16x32_bf16 v[164:167], v[76:79], v[12:15], v[164:167]
    ds_read_b128 v[104:107], v185 offset:8192
    s_waitcnt lgkmcnt(6)
    v_mfma_f32_16x16x32_bf16 v[164:167], v[80:83], v[16:19], v[164:167]
    ds_read_b128 v[108:111], v186 offset:8192
    s_waitcnt lgkmcnt(6)
    v_mfma_f32_16x16x32_bf16 v[164:167], v[84:87], v[20:23], v[164:167]
    ds_read_b128 v[112:115], v187 offset:8192
    s_waitcnt lgkmcnt(6)
    v_mfma_f32_16x16x32_bf16 v[164:167], v[88:91], v[24:27], v[164:167]
    ds_read_b128 v[116:119], v184 offset:12288
    s_waitcnt lgkmcnt(6)
    v_mfma_f32_16x16x32_bf16 v[164:167], v[92:95], v[28:31], v[164:167]
    ds_read_b128 v[120:123], v185 offset:12288
    s_waitcnt lgkmcnt(6)
    v_mfma_f32_16x16x32_bf16 v[164:167], v[96:99], v[32:35], v[164:167]
    ds_read_b128 v[124:127], v186 offset:12288
    s_waitcnt lgkmcnt(6)
    v_mfma_f32_16x16x32_bf16 v[164:167], v[100:103], v[36:39], v[164:167]
    ds_read_b128 v[128:131], v187 offset:12288
    s_waitcnt lgkmcnt(6)
    v_mfma_f32_16x16x32_bf16 v[164:167], v[104:107], v[40:43], v[164:167]
    s_waitcnt lgkmcnt(5)
    v_mfma_f32_16x16x32_bf16 v[164:167], v[108:111], v[44:47], v[164:167]
    s_waitcnt lgkmcnt(4)
    v_mfma_f32_16x16x32_bf16 v[164:167], v[112:115], v[48:51], v[164:167]
    s_waitcnt lgkmcnt(3)
    v_mfma_f32_16x16x32_bf16 v[164:167], v[116:119], v[52:55], v[164:167]
    s_waitcnt lgkmcnt(2)
    v_mfma_f32_16x16x32_bf16 v[164:167], v[120:123], v[56:59], v[164:167]
    s_waitcnt lgkmcnt(1)
    v_mfma_f32_16x16x32_bf16 v[164:167], v[124:127], v[60:63], v[164:167]
    s_waitcnt lgkmcnt(0)
    v_mfma_f32_16x16x32_bf16 v[164:167], v[128:131], v[64:67], v[164:167]
    v_add_u32 v218, 1, v218
    ds_write_b32 v217, v218
    s_add_u32 s53, s53, 1
    s_nop 4
    v_cvt_pk_bf16_f32 v168, v164, v165
    v_cvt_pk_bf16_f32 v169, v166, v167
    v_and_b32 v165, 0xffff0000, v168
    v_lshlrev_b32 v164, 16, v168
    v_and_b32 v167, 0xffff0000, v169
    v_lshlrev_b32 v166, 16, v169
    v_mul_f32 v164, s56, v164
    v_mul_f32 v165, s56, v165
    v_mul_f32 v166, s56, v166
    v_mul_f32 v167, s56, v167
    v_cvt_pk_bf16_f32 v168, v164, v165
    v_cvt_pk_bf16_f32 v169, v166, v167
    v_and_b32 v165, 0xffff0000, v168
    v_lshlrev_b32 v164, 16, v168
    v_and_b32 v167, 0xffff0000, v169
    v_lshlrev_b32 v166, 16, v169
    v_max3_f32 v222, v164, v165, v166
    v_max_f32 v222, v222, v167
    v_cmp_gt_f32 vcc, v222, v221
    s_cbranch_vccz L_nomax
    v_max_f32_dpp v222, v222, v222 row_ror:4 row_mask:0xf bank_mask:0xf
    s_nop 1
    v_max_f32_dpp v222, v222, v222 row_ror:8 row_mask:0xf bank_mask:0xf
    v_mov_b32 v219, v222
    s_nop 1
    v_permlane16_swap_b32 v222, v219
    v_max_f32 v222, v222, v219
    v_mov_b32 v219, v222
    s_nop 1
    v_permlane32_swap_b32 v222, v219
    v_max_f32 v222, v222, v219
    v_max_f32 v221, v221, v222
    v_mul_f32 v219, s57, v221
    v_sub_f32 v224, v176, v219
    v_mov_b32 v176, v219
    v_exp_f32 v224, v224
    s_nop 0
    v_mul_f32 v178, v178, v224
    v_pk_mul_f32 v[132:133], v[132:133], v[224:225] op_sel_hi:[1,0]
    v_pk_mul_f32 v[134:135], v[134:135], v[224:225] op_sel_hi:[1,0]
    v_pk_mul_f32 v[136:137], v[136:137], v[224:225] op_sel_hi:[1,0]
    v_pk_mul_f32 v[138:139], v[138:139], v[224:225] op_sel_hi:[1,0]
    v_pk_mul_f32 v[140:141], v[140:141], v[224:225] op_sel_hi:[1,0]
    v_pk_mul_f32 v[142:143], v[142:143], v[224:225] op_sel_hi:[1,0]
    v_pk_mul_f32 v[144:145], v[144:145], v[224:225] op_sel_hi:[1,0]
    v_pk_mul_f32 v[146:147], v[146:147], v[224:225] op_sel_hi:[1,0]
    v_pk_mul_f32 v[148:149], v[148:149], v[224:225] op_sel_hi:[1,0]
    v_pk_mul_f32 v[150:151], v[150:151], v[224:225] op_sel_hi:[1,0]
    v_pk_mul_f32 v[152:153], v[152:153], v[224:225] op_sel_hi:[1,0]
    v_pk_mul_f32 v[154:155], v[154:155], v[224:225] op_sel_hi:[1,0]
    v_pk_mul_f32 v[156:157], v[156:157], v[224:225] op_sel_hi:[1,0]
    v_pk_mul_f32 v[158:159], v[158:159], v[224:225] op_sel_hi:[1,0]
    v_pk_mul_f32 v[160:161], v[160:161], v[224:225] op_sel_hi:[1,0]
    v_pk_mul_f32 v[162:163], v[162:163], v[224:225] op_sel_hi:[1,0]
L_nomax:
    v_fma_f32 v164, v164, s57, -v176
    v_fma_f32 v165, v165, s57, -v176
    v_fma_f32 v166, v166, s57, -v176
    v_fma_f32 v167, v167, s57, -v176
    v_exp_f32 v164, v164
    v_exp_f32 v165, v165
    v_exp_f32 v166, v166
    v_exp_f32 v167, v167
    v_cvt_pk_bf16_f32 v168, v164, v165
    v_cvt_pk_bf16_f32 v169, v166, v167
    v_add_f32 v164, v164, v165
    v_add_f32 v166, v166, v167
    v_mov_b32_dpp v170, v168 row_shl:4 row_mask:0xf bank_mask:0xf bound_ctrl:0
    v_mov_b32_dpp v171, v169 row_shl:4 row_mask:0xf bank_mask:0xf bound_ctrl:0
    v_mov_b32_dpp v172, v168 row_shl:8 row_mask:0xf bank_mask:0xf bound_ctrl:0
    v_mov_b32_dpp v173, v169 row_shl:8 row_mask:0xf bank_mask:0xf bound_ctrl:0
    v_mov_b32_dpp v174, v168 row_shl:12 row_mask:0xf bank_mask:0xf bound_ctrl:0
    v_mov_b32_dpp v175, v169 row_shl:12 row_mask:0xf bank_mask:0xf bound_ctrl:0
    v_add_f32 v178, v178, v164
    v_add_f32 v178, v178, v166
    s_cmp_lt_u32 s55, s14
    s_cbranch_scc1 L_pv
    v_mov_b32 v220, 1540
    ds_read_b32 v220, v220
    v_add_f32_dpp v178, v178, v178 row_ror:4 row_mask:0xf bank_mask:0xf
    s_nop 1
    v_add_f32_dpp v178, v178, v178 row_ror:8 row_mask:0xf bank_mask:0xf
    v_mov_b32 v219, v178
    s_nop 1
    v_permlane16_swap_b32 v178, v219
    v_add_f32 v178, v178, v219
    v_mov_b32 v219, v178
    s_nop 1
    v_permlane32_swap_b32 v178, v219
    v_add_f32 v178, v178, v219
    s_waitcnt lgkmcnt(0)
    v_readfirstlane_b32 s45, v220
    s_mov_b64 exec, 15
    s_cmp_eq_u32 s45, 1
    s_cbranch_scc0 L_mfar
    buffer_store_dwordx4 v[176:179], v227, s[36:39], 0 offen
L_mdone:
    s_mov_b64 exec, -1
L_pv:
    s_cmp_ge_i32 s52, s53
    s_cbranch_scc1 L_ok57
L_poll58:
    ds_read_b32 v219, v216
    s_sub_u32 s33, s33, 1
    s_cbranch_scc1 L_end
    s_waitcnt lgkmcnt(0)
    v_readfirstlane_b32 s52, v219
    s_cmp_lt_i32 s52, s53
    s_cbranch_scc1 L_poll58
L_ok57:
    ds_read_b64_tr_b16 v[68:69], v188 offset:0
    ds_read_b64_tr_b16 v[70:71], v188 offset:4096
    ds_read_b64_tr_b16 v[72:73], v189 offset:0
    ds_read_b64_tr_b16 v[74:75], v189 offset:4096
    ds_read_b64_tr_b16 v[76:77], v190 offset:0
    ds_read_b64_tr_b16 v[78:79], v190 offset:4096
    ds_read_b64_tr_b16 v[80:81], v191 offset:0
    ds_read_b64_tr_b16 v[82:83], v191 offset:4096
    ds_read_b64_tr_b16 v[84:85], v192 offset:0
    ds_read_b64_tr_b16 v[86:87], v192 offset:4096
    ds_read_b64_tr_b16 v[88:89], v193 offset:0
    ds_read_b64_tr_b16 v[90:91], v193 offset:4096
    s_waitcnt lgkmcnt(10)
    v_mfma_f32_16x16x32_bf16 v[132:135], v[68:71], v[168:171], v[132:135]
    ds_read_b64_tr_b16 v[92:93], v194 offset:0
    ds_read_b64_tr_b16 v[94:95], v194 offset:4096
    s_waitcnt lgkmcnt(10)
    v_mfma_f32_16x16x32_bf16 v[136:139], v[72:75], v[168:171], v[136:139]
    ds_read_b64_tr_b16 v[96:97], v195 offset:0
    ds_read_b64_tr_b16 v[98:99], v195 offset:4096
    s_waitcnt lgkmcnt(10)
    v_mfma_f32_16x16x32_bf16 v[140:143], v[76:79], v[168:171], v[140:143]
    s_add_u32 s53, s53, 1
    s_waitcnt lgkmcnt(8)
    v_mfma_f32_16x16x32_bf16 v[144:147], v[80:83], v[168:171], v[144:147]
    s_waitcnt lgkmcnt(6)
    v_mfma_f32_16x16x32_bf16 v[148:151], v[84:87], v[168:171], v[148:151]
    s_waitcnt lgkmcnt(4)
    v_mfma_f32_16x16x32_bf16 v[152:155], v[88:91], v[168:171], v[152:155]
    s_waitcnt lgkmcnt(2)
    v_mfma_f32_16x16x32_bf16 v[156:159], v[92:95], v[168:171], v[156:159]
    s_waitcnt lgkmcnt(0)
    v_mfma_f32_16x16x32_bf16 v[160:163], v[96:99], v[168:171], v[160:163]
    s_cmp_ge_i32 s52, s53
    s_cbranch_scc1 L_ok59
L_poll60:
    ds_read_b32 v219, v216
    s_sub_u32 s33, s33, 1
    s_cbranch_scc1 L_end
    s_waitcnt lgkmcnt(0)
    v_readfirstlane_b32 s52, v219
    s_cmp_lt_i32 s52, s53
    s_cbranch_scc1 L_poll60
L_ok59:
    ds_read_b64_tr_b16 v[100:101], v188 offset:8192
    ds_read_b64_tr_b16 v[102:103], v188 offset:12288
    ds_read_b64_tr_b16 v[104:105], v189 offset:8192
    ds_read_b64_tr_b16 v[106:107], v189 offset:12288
    ds_read_b64_tr_b16 v[108:109], v190 offset:8192
    ds_read_b64_tr_b16 v[110:111], v190 offset:12288
    ds_read_b64_tr_b16 v[112:113], v191 offset:8192
    ds_read_b64_tr_b16 v[114:115], v191 offset:12288
    ds_read_b64_tr_b16 v[116:117], v192 offset:8192
    ds_read_b64_tr_b16 v[118:119], v192 offset:12288
    ds_read_b64_tr_b16 v[120:121], v193 offset:8192
    ds_read_b64_tr_b16 v[122:123], v193 offset:12288
    s_waitcnt lgkmcnt(10)
    v_mfma_f32_16x16x32_bf16 v[132:135], v[100:103], v[172:175], v[132:135]
    ds_read_b64_tr_b16 v[124:125], v194 offset:8192
    ds_read_b64_tr_b16 v[126:127], v194 offset:12288
    s_waitcnt lgkmcnt(10)
    v_mfma_f32_16x16x32_bf16 v[136:139], v[104:107], v[172:175], v[136:139]
    ds_read_b64_tr_b16 v[128:129], v195 offset:8192
    ds_read_b64_tr_b16 v[130:131], v195 offset:12288
    s_waitcnt lgkmcnt(10)
    v_mfma_f32_16x16x32_bf16 v[140:143], v[108:111], v[172:175], v[140:143]
    s_add_u32 s53, s53, 2
    s_waitcnt lgkmcnt(8)
    v_mfma_f32_16x16x32_bf16 v[144:147], v[112:115], v[172:175], v[144:147]
    s_waitcnt lgkmcnt(6)
    v_mfma_f32_16x16x32_bf16 v[148:151], v[116:119], v[172:175], v[148:151]
    s_waitcnt lgkmcnt(4)
    v_mfma_f32_16x16x32_bf16 v[152:155], v[120:123], v[172:175], v[152:155]
    s_waitcnt lgkmcnt(2)
    v_mfma_f32_16x16x32_bf16 v[156:159], v[124:127], v[172:175], v[156:159]
    s_waitcnt lgkmcnt(0)
    v_mfma_f32_16x16x32_bf16 v[160:163], v[128:131], v[172:175], v[160:163]
    v_add_u32 v218, 1, v218
    ds_write_b32 v217, v218
    s_add_u32 s55, s55, 1
    s_cmp_le_u32 s55, s14
    s_cbranch_scc1 L_loop
    s_mov_b32 exec_lo, 0x000f000f
    s_mov_b32 exec_hi, 0x000f000f
    s_cmp_eq_u32 s45, 1
    s_cbranch_scc0 L_ofar
    v_and_or_b32 v132, v132, s44, v180
    v_and_or_b32 v133, v133, s44, v181
    v_and_or_b32 v134, v134, s44, v182
    v_and_or_b32 v135, v135, s44, v183
    buffer_store_dwordx4 v[132:135], v226, s[36:39], s60 offen offset:0
    v_and_or_b32 v136, v136, s44, v180
    v_and_or_b32 v137, v137, s44, v181
    v_and_or_b32 v138, v138, s44, v182
    v_and_or_b32 v139, v139, s44, v183
    buffer_store_dwordx4 v[136:139], v226, s[36:39], s60 offen offset:2048
    v_and_or_b32 v140, v140, s44, v180
    v_and_or_b32 v141, v141, s44, v181
    v_and_or_b32 v142, v142, s44, v182
    v_and_or_b32 v143, v143, s44, v183
    buffer_store_dwordx4 v[140:143], v226, s[36:39], s61 offen offset:0
    v_and_or_b32 v144, v144, s44, v180
    v_and_or_b32 v145, v145, s44, v181
    v_and_or_b32 v146, v146, s44, v182
    v_and_or_b32 v147, v147, s44, v183
    buffer_store_dwordx4 v[144:147], v226, s[36:39], s61 offen offset:2048
    v_and_or_b32 v148, v148, s44, v180
    v_and_or_b32 v149, v149, s44, v181
    v_and_or_b32 v150, v150, s44, v182
    v_and_or_b32 v151, v151, s44, v183
    buffer_store_dwordx4 v[148:151], v226, s[36:39], s62 offen offset:0
    v_and_or_b32 v152, v152, s44, v180
    v_and_or_b32 v153, v153, s44, v181
    v_and_or_b32 v154, v154, s44, v182
    v_and_or_b32 v155, v155, s44, v183
    buffer_store_dwordx4 v[152:155], v226, s[36:39], s62 offen offset:2048
    v_and_or_b32 v156, v156, s44, v180
    v_and_or_b32 v157, v157, s44, v181
    v_and_or_b32 v158, v158, s44, v182
    v_and_or_b32 v159, v159, s44, v183
    buffer_store_dwordx4 v[156:159], v226, s[36:39], s63 offen offset:0
    v_and_or_b32 v160, v160, s44, v180
    v_and_or_b32 v161, v161, s44, v181
    v_and_or_b32 v162, v162, s44, v182
    v_and_or_b32 v163, v163, s44, v183
    buffer_store_dwordx4 v[160:163], v226, s[36:39], s63 offen offset:2048
L_odone:
    s_endpgm
L_mfar:
    buffer_store_dwordx4 v[176:179], v227, s[36:39], 0 offen sc1
    s_branch L_mdone
L_ofar:
    v_and_or_b32 v132, v132, s44, v180
    v_and_or_b32 v133, v133, s44, v181
    v_and_or_b32 v134, v134, s44, v182
    v_and_or_b32 v135, v135, s44, v183
    buffer_store_dwordx4 v[132:135], v226, s[36:39], s60 offen offset:0 sc1
    v_and_or_b32 v136, v136, s44, v180
    v_and_or_b32 v137, v137, s44, v181
    v_and_or_b32 v138, v138, s44, v182
    v_and_or_b32 v139, v139, s44, v183
    buffer_store_dwordx4 v[136:139], v226, s[36:39], s60 offen offset:2048 sc1
    v_and_or_b32 v140, v140, s44, v180
    v_and_or_b32 v141, v141, s44, v181
    v_and_or_b32 v142, v142, s44, v182
    v_and_or_b32 v143, v143, s44, v183
    buffer_store_dwordx4 v[140:143], v226, s[36:39], s61 offen offset:0 sc1
    v_and_or_b32 v144, v144, s44, v180
    v_and_or_b32 v145, v145, s44, v181
    v_and_or_b32 v146, v146, s44, v182
    v_and_or_b32 v147, v147, s44, v183
    buffer_store_dwordx4 v[144:147], v226, s[36:39], s61 offen offset:2048 sc1
    v_and_or_b32 v148, v148, s44, v180
    v_and_or_b32 v149, v149, s44, v181
    v_and_or_b32 v150, v150, s44, v182
    v_and_or_b32 v151, v151, s44, v183
    buffer_store_dwordx4 v[148:151], v226, s[36:39], s62 offen offset:0 sc1
    v_and_or_b32 v152, v152, s44, v180
    v_and_or_b32 v153, v153, s44, v181
    v_and_or_b32 v154, v154, s44, v182
    v_and_or_b32 v155, v155, s44, v183
    buffer_store_dwordx4 v[152:155], v226, s[36:39], s62 offen offset:2048 sc1
    v_and_or_b32 v156, v156, s44, v180
    v_and_or_b32 v157, v157, s44, v181
    v_and_or_b32 v158, v158, s44, v182
    v_and_or_b32 v159, v159, s44, v183
    buffer_store_dwordx4 v[156:159], v226, s[36:39], s63 offen offset:0 sc1
    v_and_or_b32 v160, v160, s44, v180
    v_and_or_b32 v161, v161, s44, v181
    v_and_or_b32 v162, v162, s44, v182
    v_and_or_b32 v163, v163, s44, v183
    buffer_store_dwordx4 v[160:163], v226, s[36:39], s63 offen offset:2048 sc1
    s_branch L_odone
L_proj:
    s_add_u32 s30, s2, 0
    s_and_b32 s30, s30, 7
    v_mov_b32 v153, 1024
    s_mov_b32 s52, -64
    s_mov_b32 s45, 0xfffffc00
    v_mov_b32 v162, 1536
    v_mov_b32 v154, 20
    v_mov_b32 v155, 0
    ds_write_b64 v162, v[154:155]
    s_waitcnt lgkmcnt(0)
    s_load_dword s44, s[28:29], 0x8000
    s_barrier
    s_waitcnt lgkmcnt(0)
    s_mul_i32 s44, s44, 0x9e3779b1
    s_add_u32 s44, s44, 0x7f4a7c15
    s_mov_b32 s36, s28
    s_mov_b32 s37, s29
    s_mov_b32 s38, 3145728
    s_mov_b32 s39, 0x00020000
    s_bfe_u32 s34, s44, 0xa0000
    v_mov_b32 v116, s34
    s_bfe_u32 s34, s44, 0xa0008
    v_mov_b32 v117, s34
    s_bfe_u32 s34, s44, 0xa0010
    v_mov_b32 v118, s34
    s_bfe_u32 s34, s44, 0xa0016
    v_mov_b32 v119, s34
    v_mov_b32 v170, 0xffff0000
    v_cmp_eq_u32 vcc, 1, v1
    s_nop 1
    v_cndmask_b32 v166, 0, v170, vcc
    v_cmp_eq_u32 vcc, 3, v1
    s_nop 1
    v_cndmask_b32 v167, 0, v170, vcc
    v_cmp_eq_u32 vcc, 5, v1
    s_nop 1
    v_cndmask_b32 v168, 0, v170, vcc
    v_cmp_eq_u32 vcc, 7, v1
    s_nop 1
    v_cndmask_b32 v169, 0, v170, vcc
    v_mov_b32 v170, 0xffff
    v_cmp_eq_u32 vcc, 0, v1
    s_nop 1
    v_cndmask_b32 v166, v166, v170, vcc
    v_cmp_eq_u32 vcc, 2, v1
    s_nop 1
    v_cndmask_b32 v167, v167, v170, vcc
    v_cmp_eq_u32 vcc, 4, v1
    s_nop 1
    v_cndmask_b32 v168, v168, v170, vcc
    v_cmp_eq_u32 vcc, 6, v1
    s_nop 1
    v_cndmask_b32 v169, v169, v170, vcc
    s_lshl_b32 s46, s14, 1
    s_add_u32 s46, s46, s32
    s_mul_i32 s34, s46, 7282
    s_lshr_b32 s34, s34, 16
    s_mul_i32 s34, s34, 9
    s_sub_u32 s34, s46, s34
    s_lshl_b32 s34, s34, 14
    s_add_u32 s34, s34, 2048
    s_lshl_b32 s46, s46, 1
    v_lshlrev_b32 v157, 4, v1
    v_lshl_add_u32 v157, v2, 10, v157
    v_add_u32 v157, s34, v157
    s_lshl_b32 s53, s30, 2
    s_lshr_b32 s54, s31, 3
    s_add_u32 s53, s53, s54
    s_lshl_b32 s53, s53, 9
    s_add_u32 s53, s53, 16384
    v_lshrrev_b32 v158, 2, v0
    v_lshlrev_b32 v158, 4, v158
    v_lshlrev_b32 v159, 4, v0
    s_lshl_b32 s54, s30, 16
    s_lshl_b32 s55, s31, 11
    s_add_u32 s54, s54, s55
    s_add_u32 s54, s54, 65536
    v_lshl_add_u32 v156, v1, 1, v2
    s_and_b32 s35, s2, 7
    s_lshl_b32 s35, s35, 2
    s_and_b32 s34, s31, 3
    s_add_u32 s35, s35, s34
    s_and_b32 s34, s2, 0xe0
    s_add_u32 s35, s35, s34
    s_and_b32 s34, s2, 7
    s_lshl_b32 s34, s34, 3
    s_lshl_b64 s[50:51], 0xff, s34
    v_lshrrev_b32 v154, 1, v156
    v_mul_u32_u24 v154, 8192, v154
    v_and_b32 v160, 1, v156
    v_lshlrev_b32 v160, 4, v160
    v_add_u32 v160, v160, v154
    s_mul_i32 s34, s35, 32
    s_add_u32 s34, s34, 1048576
    v_add_u32 v160, s34, v160
    s_mov_b32 s60, 131072
    s_mov_b32 s61, 262144
    s_mov_b32 s62, 393216
    s_getreg_b32 s63, hwreg(HW_REG_XCC_ID)
    s_lshl_b32 s59, s30, 8
    s_add_u32 s59, s59, 753664
    s_lshl_b32 s34, s31, 3
    v_mov_b32 v156, s34
    v_mov_b32 v154, s44
    v_mov_b32 v155, s63
    s_mov_b64 exec, 1
    buffer_store_dwordx2 v[154:155], v156, s[36:39], s59 offen
    s_waitcnt vmcnt(0)
    s_mov_b64 exec, -1
    s_sub_u32 s47, s2, 0
    s_and_b32 s35, s47, 63
    s_mul_i32 s55, s35, 8192
    s_add_u32 s55, s55, 1048576
    s_add_u32 s56, s55, 4096
    s_mul_i32 s57, s35, 1024
    s_add_u32 s57, s57, 2097152
    s_mul_i32 s34, s35, 16
    v_and_b32 v163, 1, v0
    v_lshl_add_u32 v163, v163, 2, v2
    v_lshlrev_b32 v163, 1, v163
    v_add_u32 v163, s34, v163
    s_bfe_u32 s34, s2, 0x10002
    s_lshl_b32 s34, s34, 12
    s_lshl_b32 s35, s31, 7
    s_add_u32 s35, s35, s34
    s_xor_b32 s34, s34, 4096
    s_and_b32 s48, s2, 3
    s_lshr_b32 s49, s2, 1
    s_and_b32 s49, s49, 0
    s_add_u32 s48, s48, s49
    s_lshl_b32 s48, s48, 2
    s_add_u32 s35, s35, s48
    v_mov_b32 v173, s35
    v_mul_u32_u24 v172, 5, v0
    v_add_u32 v172, s31, v172
    v_and_b32 v172, 31, v172
    v_lshlrev_b32 v172, 7, v172
    v_add_u32 v172, s34, v172
    s_sub_u32 s35, s46, 84
    s_cmp_ge_i32 s52, s35
    s_cbranch_scc1 L_ok61
L_poll62:
    ds_read_b32 v154, v153
    s_sub_u32 s33, s33, 1
    s_cbranch_scc1 L_end
    s_sleep 2
    s_waitcnt lgkmcnt(0)
    v_readfirstlane_b32 s52, v154
    s_cmp_lt_i32 s52, s35
    s_cbranch_scc1 L_poll62
L_ok61:
    s_mov_b32 s34, 655360
    v_mov_b32 v154, s44
    s_mov_b64 exec, 1
    buffer_store_dword v154, v173, s[36:39], s34 offen sc1
    v_readlane_b32 s35, v172, 0
    s_add_u32 s35, s35, s34
    s_load_dwordx4 s[64:67], s[28:29], s35
    v_readlane_b32 s35, v172, 1
    s_add_u32 s35, s35, s34
    s_load_dwordx4 s[68:71], s[28:29], s35
    v_readlane_b32 s35, v172, 2
    s_add_u32 s35, s35, s34
    s_load_dwordx4 s[72:75], s[28:29], s35
    v_readlane_b32 s35, v172, 3
    s_add_u32 s35, s35, s34
    s_load_dwordx4 s[76:79], s[28:29], s35
    v_readlane_b32 s35, v172, 4
    s_add_u32 s35, s35, s34
    s_load_dwordx4 s[8:11], s[28:29], s35
    v_readlane_b32 s35, v172, 5
    s_add_u32 s35, s35, s34
    s_load_dwordx4 s[16:19], s[28:29], s35
    s_mov_b32 s34, 0
    s_waitcnt lgkmcnt(0)
    s_cmp_eq_u32 s64, s44
    s_addc_u32 s34, s34, 0
    s_cmp_eq_u32 s65, s44
    s_addc_u32 s34, s34, 0
    s_cmp_eq_u32 s66, s44
    s_addc_u32 s34, s34, 0
    s_cmp_eq_u32 s67, s44
    s_addc_u32 s34, s34, 0
    s_cmp_eq_u32 s68, s44
    s_addc_u32 s34, s34, 0
    s_cmp_eq_u32 s69, s44
    s_addc_u32 s34, s34, 0
    s_cmp_eq_u32 s70, s44
    s_addc_u32 s34, s34, 0
    s_cmp_eq_u32 s71, s44
    s_addc_u32 s34, s34, 0
    s_cmp_eq_u32 s72, s44
    s_addc_u32 s34, s34, 0
    s_cmp_eq_u32 s73, s44
    s_addc_u32 s34, s34, 0
    s_cmp_eq_u32 s74, s44
    s_addc_u32 s34, s34, 0
    s_cmp_eq_u32 s75, s44
    s_addc_u32 s34, s34, 0
    s_cmp_eq_u32 s76, s44
    s_addc_u32 s34, s34, 0
    s_cmp_eq_u32 s77, s44
    s_addc_u32 s34, s34, 0
    s_cmp_eq_u32 s78, s44
    s_addc_u32 s34, s34, 0
    s_cmp_eq_u32 s79, s44
    s_addc_u32 s34, s34, 0
    s_cmp_eq_u32 s8, s44
    s_addc_u32 s34, s34, 0
    s_cmp_eq_u32 s9, s44
    s_addc_u32 s34, s34, 0
    s_cmp_eq_u32 s10, s44
    s_addc_u32 s34, s34, 0
    s_cmp_eq_u32 s11, s44
    s_addc_u32 s34, s34, 0
    s_cmp_eq_u32 s16, s44
    s_addc_u32 s34, s34, 0
    s_cmp_eq_u32 s17, s44
    s_addc_u32 s34, s34, 0
    s_cmp_eq_u32 s18, s44
    s_addc_u32 s34, s34, 0
    s_cmp_eq_u32 s19, s44
    s_addc_u32 s34, s34, 0
    s_mov_b32 s35, 18
    s_cmp_ge_u32 s34, 2
    s_cselect_b32 s35, 19, s35
    s_cmp_ge_u32 s34, 7
    s_cselect_b32 s35, 20, s35
    s_cmp_ge_u32 s34, 14
    s_cselect_b32 s35, 21, s35
    s_cmp_ge_u32 s34, 19
    s_cselect_b32 s35, 23, s35
    s_cmp_ge_u32 s34, 22
    s_cselect_b32 s35, 26, s35
    v_mov_b32 v154, s35
    ds_write_b32 v162, v154
    s_mov_b64 exec, -1
    v_lshlrev_b32 v156, 3, v0
    s_mov_b32 exec_hi, 0
    buffer_load_dwordx2 v[154:155], v156, s[36:39], s59 offen sc1
    s_waitcnt vmcnt(0)
    v_xor_b32 v154, s44, v154
    v_xor_b32 v155, s63, v155
    v_or_b32 v154, v154, v155
    v_cmp_ne_u32 vcc, 0, v154
    s_cmp_eq_u64 vcc, 0
    s_cselect_b32 s63, 1, 0
    v_mov_b32 v154, s63
    ds_write_b32 v162, v154 offset:4
    s_mov_b32 exec_hi, -1
    s_cmp_ge_u32 s47, 64
    s_cbranch_scc1 L_nobg
    s_sub_u32 s35, s46, 76
    s_cmp_ge_i32 s52, s35
    s_cbranch_scc1 L_ok63
L_poll64:
    ds_read_b32 v154, v153
    s_sub_u32 s33, s33, 1
    s_cbranch_scc1 L_end
    s_sleep 16
    s_waitcnt lgkmcnt(0)
    v_readfirstlane_b32 s52, v154
    s_cmp_lt_i32 s52, s35
    s_cbranch_scc1 L_poll64
L_ok63:
    global_load_ushort v164, v163, s[4:5]
    global_load_ushort v165, v163, s[22:23]
    v_mov_b32 v120, 0
    v_mov_b32 v121, 0
    v_mov_b32 v122, 0
    v_mov_b32 v123, 0
    s_mov_b32 exec_lo, 0xffffffff
    s_mov_b32 exec_hi, 0xffffff
L_gb:
    buffer_load_dwordx4 v[120:123], v159, s[36:39], s57 offen offset:0 sc1
    s_sub_u32 s33, s33, 1
    s_cbranch_scc1 L_end
L_chk65:
    s_waitcnt vmcnt(0)
    v_xor_b32 v120, v120, v116
    v_xor_b32 v121, v121, v117
    v_xor_b32 v122, v122, v118
    v_xor_b32 v123, v123, v119
    v_or_b32 v152, v120, v121
    v_or3_b32 v152, v152, v122, v123
    v_and_b32 v152, 1023, v152
    v_cmp_ne_u32 vcc, 0, v152
    s_mov_b64 exec, vcc
    s_cbranch_execnz L_gb
    s_mov_b64 exec, -1
    v_permlane32_swap_b32 v120, v122
    v_permlane32_swap_b32 v121, v123
    v_add_f32 v120, v120, v122
    v_add_f32 v121, v121, v123
    s_nop 1
    v_permlane16_swap_b32 v120, v121
    v_add_f32 v120, v120, v121
    s_nop 1
    v_add_f32_dpp v120, v120, v120 row_ror:2 row_mask:0xf bank_mask:0xf
    s_nop 1
    v_add_f32_dpp v120, v120, v120 row_ror:4 row_mask:0xf bank_mask:0xf
    s_nop 1
    v_add_f32_dpp v120, v120, v120 row_ror:8 row_mask:0xf bank_mask:0xf
    v_cvt_pk_bf16_f32 v120, v120, v120
    v_lshlrev_b32 v120, 16, v120
    v_lshlrev_b32 v164, 16, v164
    v_lshlrev_b32 v165, 16, v165
    v_add_f32 v165, v165, v120
    v_cvt_pk_bf16_f32 v165, v165, v165
    v_lshlrev_b32 v165, 16, v165
L_nobg:
    s_sub_u32 s35, s46, 56
    s_cmp_ge_i32 s52, s35
    s_cbranch_scc1 L_ok67
L_poll68:
    ds_read_b32 v154, v153
    s_sub_u32 s33, s33, 1
    s_cbranch_scc1 L_end
    s_sleep 2
    s_waitcnt lgkmcnt(0)
    v_readfirstlane_b32 s52, v154
    s_cmp_lt_i32 s52, s35
    s_cbranch_scc1 L_poll68
L_ok67:
    s_mov_b32 s34, 663552
    v_mov_b32 v154, s44
    s_mov_b64 exec, 1
    buffer_store_dword v154, v173, s[36:39], s34 offen sc1
    v_readlane_b32 s35, v172, 0
    s_add_u32 s35, s35, s34
    s_load_dwordx4 s[64:67], s[28:29], s35
    v_readlane_b32 s35, v172, 1
    s_add_u32 s35, s35, s34
    s_load_dwordx4 s[68:71], s[28:29], s35
    v_readlane_b32 s35, v172, 2
    s_add_u32 s35, s35, s34
    s_load_dwordx4 s[72:75], s[28:29], s35
    v_readlane_b32 s35, v172, 3
    s_add_u32 s35, s35, s34
    s_load_dwordx4 s[76:79], s[28:29], s35
    v_readlane_b32 s35, v172, 4
    s_add_u32 s35, s35, s34
    s_load_dwordx4 s[8:11], s[28:29], s35
    v_readlane_b32 s35, v172, 5
    s_add_u32 s35, s35, s34
    s_load_dwordx4 s[16:19], s[28:29], s35
    s_mov_b32 s34, 0
    s_waitcnt lgkmcnt(0)
    s_cmp_eq_u32 s64, s44
    s_addc_u32 s34, s34, 0
    s_cmp_eq_u32 s65, s44
    s_addc_u32 s34, s34, 0
    s_cmp_eq_u32 s66, s44
    s_addc_u32 s34, s34, 0
    s_cmp_eq_u32 s67, s44
    s_addc_u32 s34, s34, 0
    s_cmp_eq_u32 s68, s44
    s_addc_u32 s34, s34, 0
    s_cmp_eq_u32 s69, s44
    s_addc_u32 s34, s34, 0
    s_cmp_eq_u32 s70, s44
    s_addc_u32 s34, s34, 0
    s_cmp_eq_u32 s71, s44
    s_addc_u32 s34, s34, 0
    s_cmp_eq_u32 s72, s44
    s_addc_u32 s34, s34, 0
    s_cmp_eq_u32 s73, s44
    s_addc_u32 s34, s34, 0
    s_cmp_eq_u32 s74, s44
    s_addc_u32 s34, s34, 0
    s_cmp_eq_u32 s75, s44
    s_addc_u32 s34, s34, 0
    s_cmp_eq_u32 s76, s44
    s_addc_u32 s34, s34, 0
    s_cmp_eq_u32 s77, s44
    s_addc_u32 s34, s34, 0
    s_cmp_eq_u32 s78, s44
    s_addc_u32 s34, s34, 0
    s_cmp_eq_u32 s79, s44
    s_addc_u32 s34, s34, 0
    s_cmp_eq_u32 s8, s44
    s_addc_u32 s34, s34, 0
    s_cmp_eq_u32 s9, s44
    s_addc_u32 s34, s34, 0
    s_cmp_eq_u32 s10, s44
    s_addc_u32 s34, s34, 0
    s_cmp_eq_u32 s11, s44
    s_addc_u32 s34, s34, 0
    s_cmp_eq_u32 s16, s44
    s_addc_u32 s34, s34, 0
    s_cmp_eq_u32 s17, s44
    s_addc_u32 s34, s34, 0
    s_cmp_eq_u32 s18, s44
    s_addc_u32 s34, s34, 0
    s_cmp_eq_u32 s19, s44
    s_addc_u32 s34, s34, 0
    s_mov_b32 s35, 18
    s_cmp_ge_u32 s34, 2
    s_cselect_b32 s35, 19, s35
    s_cmp_ge_u32 s34, 7
    s_cselect_b32 s35, 20, s35
    s_cmp_ge_u32 s34, 14
    s_cselect_b32 s35, 21, s35
    s_cmp_ge_u32 s34, 19
    s_cselect_b32 s35, 23, s35
    s_cmp_ge_u32 s34, 22
    s_cselect_b32 s35, 26, s35
    v_mov_b32 v154, s35
    ds_write_b32 v162, v154
    s_mov_b64 exec, -1
    s_sub_u32 s35, s46, 32
    s_cmp_ge_i32 s52, s35
    s_cbranch_scc1 L_ok69
L_poll70:
    ds_read_b32 v154, v153
    s_sub_u32 s33, s33, 1
    s_cbranch_scc1 L_end
    s_sleep 2
    s_waitcnt lgkmcnt(0)
    v_readfirstlane_b32 s52, v154
    s_cmp_lt_i32 s52, s35
    s_cbranch_scc1 L_poll70
L_ok69:
    s_mov_b32 s34, 671744
    v_mov_b32 v154, s44
    s_mov_b64 exec, 1
    buffer_store_dword v154, v173, s[36:39], s34 offen sc1
    v_readlane_b32 s35, v172, 0
    s_add_u32 s35, s35, s34
    s_load_dwordx4 s[64:67], s[28:29], s35
    v_readlane_b32 s35, v172, 1
    s_add_u32 s35, s35, s34
    s_load_dwordx4 s[68:71], s[28:29], s35
    v_readlane_b32 s35, v172, 2
    s_add_u32 s35, s35, s34
    s_load_dwordx4 s[72:75], s[28:29], s35
    v_readlane_b32 s35, v172, 3
    s_add_u32 s35, s35, s34
    s_load_dwordx4 s[76:79], s[28:29], s35
    v_readlane_b32 s35, v172, 4
    s_add_u32 s35, s35, s34
    s_load_dwordx4 s[8:11], s[28:29], s35
    v_readlane_b32 s35, v172, 5
    s_add_u32 s35, s35, s34
    s_load_dwordx4 s[16:19], s[28:29], s35
    s_mov_b32 s34, 0
    s_waitcnt lgkmcnt(0)
    s_cmp_eq_u32 s64, s44
    s_addc_u32 s34, s34, 0
    s_cmp_eq_u32 s65, s44
    s_addc_u32 s34, s34, 0
    s_cmp_eq_u32 s66, s44
    s_addc_u32 s34, s34, 0
    s_cmp_eq_u32 s67, s44
    s_addc_u32 s34, s34, 0
    s_cmp_eq_u32 s68, s44
    s_addc_u32 s34, s34, 0
    s_cmp_eq_u32 s69, s44
    s_addc_u32 s34, s34, 0
    s_cmp_eq_u32 s70, s44
    s_addc_u32 s34, s34, 0
    s_cmp_eq_u32 s71, s44
    s_addc_u32 s34, s34, 0
    s_cmp_eq_u32 s72, s44
    s_addc_u32 s34, s34, 0
    s_cmp_eq_u32 s73, s44
    s_addc_u32 s34, s34, 0
    s_cmp_eq_u32 s74, s44
    s_addc_u32 s34, s34, 0
    s_cmp_eq_u32 s75, s44
    s_addc_u32 s34, s34, 0
    s_cmp_eq_u32 s76, s44
    s_addc_u32 s34, s34, 0
    s_cmp_eq_u32 s77, s44
    s_addc_u32 s34, s34, 0
    s_cmp_eq_u32 s78, s44
    s_addc_u32 s34, s34, 0
    s_cmp_eq_u32 s79, s44
    s_addc_u32 s34, s34, 0
    s_cmp_eq_u32 s8, s44
    s_addc_u32 s34, s34, 0
    s_cmp_eq_u32 s9, s44
    s_addc_u32 s34, s34, 0
    s_cmp_eq_u32 s10, s44
    s_addc_u32 s34, s34, 0
    s_cmp_eq_u32 s11, s44
    s_addc_u32 s34, s34, 0
    s_cmp_eq_u32 s16, s44
    s_addc_u32 s34, s34, 0
    s_cmp_eq_u32 s17, s44
    s_addc_u32 s34, s34, 0
    s_cmp_eq_u32 s18, s44
    s_addc_u32 s34, s34, 0
    s_cmp_eq_u32 s19, s44
    s_addc_u32 s34, s34, 0
    s_mov_b32 s35, 18
    s_cmp_ge_u32 s34, 2
    s_cselect_b32 s35, 19, s35
    s_cmp_ge_u32 s34, 7
    s_cselect_b32 s35, 20, s35
    s_cmp_ge_u32 s34, 14
    s_cselect_b32 s35, 21, s35
    s_cmp_ge_u32 s34, 19
    s_cselect_b32 s35, 23, s35
    s_cmp_ge_u32 s34, 22
    s_cselect_b32 s35, 26, s35
    v_mov_b32 v154, s35
    ds_write_b32 v162, v154
    s_mov_b64 exec, -1
    s_sub_u32 s35, s46, 16
    s_cmp_ge_i32 s52, s35
    s_cbranch_scc1 L_ok71
L_poll72:
    ds_read_b32 v154, v153
    s_sub_u32 s33, s33, 1
    s_cbranch_scc1 L_end
    s_sleep 2
    s_waitcnt lgkmcnt(0)
    v_readfirstlane_b32 s52, v154
    s_cmp_lt_i32 s52, s35
    s_cbranch_scc1 L_poll72
L_ok71:
    s_mov_b32 s34, 679936
    v_mov_b32 v154, s44
    s_mov_b64 exec, 1
    buffer_store_dword v154, v173, s[36:39], s34 offen sc1
    v_readlane_b32 s35, v172, 0
    s_add_u32 s35, s35, s34
    s_load_dwordx4 s[64:67], s[28:29], s35
    v_readlane_b32 s35, v172, 1
    s_add_u32 s35, s35, s34
    s_load_dwordx4 s[68:71], s[28:29], s35
    v_readlane_b32 s35, v172, 2
    s_add_u32 s35, s35, s34
    s_load_dwordx4 s[72:75], s[28:29], s35
    v_readlane_b32 s35, v172, 3
    s_add_u32 s35, s35, s34
    s_load_dwordx4 s[76:79], s[28:29], s35
    v_readlane_b32 s35, v172, 4
    s_add_u32 s35, s35, s34
    s_load_dwordx4 s[8:11], s[28:29], s35
    v_readlane_b32 s35, v172, 5
    s_add_u32 s35, s35, s34
    s_load_dwordx4 s[16:19], s[28:29], s35
    s_mov_b32 s34, 0
    s_waitcnt lgkmcnt(0)
    s_cmp_eq_u32 s64, s44
    s_addc_u32 s34, s34, 0
    s_cmp_eq_u32 s65, s44
    s_addc_u32 s34, s34, 0
    s_cmp_eq_u32 s66, s44
    s_addc_u32 s34, s34, 0
    s_cmp_eq_u32 s67, s44
    s_addc_u32 s34, s34, 0
    s_cmp_eq_u32 s68, s44
    s_addc_u32 s34, s34, 0
    s_cmp_eq_u32 s69, s44
    s_addc_u32 s34, s34, 0
    s_cmp_eq_u32 s70, s44
    s_addc_u32 s34, s34, 0
    s_cmp_eq_u32 s71, s44
    s_addc_u32 s34, s34, 0
    s_cmp_eq_u32 s72, s44
    s_addc_u32 s34, s34, 0
    s_cmp_eq_u32 s73, s44
    s_addc_u32 s34, s34, 0
    s_cmp_eq_u32 s74, s44
    s_addc_u32 s34, s34, 0
    s_cmp_eq_u32 s75, s44
    s_addc_u32 s34, s34, 0
    s_cmp_eq_u32 s76, s44
    s_addc_u32 s34, s34, 0
    s_cmp_eq_u32 s77, s44
    s_addc_u32 s34, s34, 0
    s_cmp_eq_u32 s78, s44
    s_addc_u32 s34, s34, 0
    s_cmp_eq_u32 s79, s44
    s_addc_u32 s34, s34, 0
    s_cmp_eq_u32 s8, s44
    s_addc_u32 s34, s34, 0
    s_cmp_eq_u32 s9, s44
    s_addc_u32 s34, s34, 0
    s_cmp_eq_u32 s10, s44
    s_addc_u32 s34, s34, 0
    s_cmp_eq_u32 s11, s44
    s_addc_u32 s34, s34, 0
    s_cmp_eq_u32 s16, s44
    s_addc_u32 s34, s34, 0
    s_cmp_eq_u32 s17, s44
    s_addc_u32 s34, s34, 0
    s_cmp_eq_u32 s18, s44
    s_addc_u32 s34, s34, 0
    s_cmp_eq_u32 s19, s44
    s_addc_u32 s34, s34, 0
    s_mov_b32 s35, 17
    s_cmp_ge_u32 s34, 2
    s_cselect_b32 s35, 18, s35
    s_cmp_ge_u32 s34, 7
    s_cselect_b32 s35, 20, s35
    s_cmp_ge_u32 s34, 14
    s_cselect_b32 s35, 23, s35
    s_cmp_ge_u32 s34, 19
    s_cselect_b32 s35, 26, s35
    s_cmp_ge_u32 s34, 22
    s_cselect_b32 s35, 30, s35
    v_mov_b32 v154, s35
    ds_write_b32 v162, v154
    s_mov_b64 exec, -1
    s_sub_u32 s35, s46, 7
    s_cmp_ge_i32 s52, s35
    s_cbranch_scc1 L_ok73
L_poll74:
    ds_read_b32 v154, v153
    s_sub_u32 s33, s33, 1
    s_cbranch_scc1 L_end
    s_sleep 16
    s_waitcnt lgkmcnt(0)
    v_readfirstlane_b32 s52, v154
    s_cmp_lt_i32 s52, s35
    s_cbranch_scc1 L_poll74
L_ok73:
    buffer_load_dwordx4 v[100:103], v159, s[36:39], s54 offen offset:0 sc1
    buffer_load_dwordx4 v[104:107], v159, s[36:39], s54 offen offset:1024 sc1
    buffer_load_dwordx4 v[108:111], v158, s[36:39], s53 offen offset:0 sc1
    buffer_load_dwordx4 v[112:115], v158, s[36:39], s53 offen offset:256 sc1
    s_waitcnt vmcnt(0)
    s_sub_u32 s35, s46, 6
    s_cmp_ge_i32 s52, s35
    s_cbranch_scc1 L_ok75
L_poll76:
    ds_read_b32 v154, v153
    s_sub_u32 s33, s33, 1
    s_cbranch_scc1 L_end
    s_sleep 16
    s_waitcnt lgkmcnt(0)
    v_readfirstlane_b32 s52, v154
    s_cmp_lt_i32 s52, s35
    s_cbranch_scc1 L_poll76
L_ok75:
    s_sub_u32 s35, s46, 0
    s_cmp_ge_i32 s52, s35
    s_cbranch_scc1 L_ok77
L_poll78:
    ds_read_b32 v154, v153
    s_sub_u32 s33, s33, 1
    s_cbranch_scc1 L_end
    s_waitcnt lgkmcnt(0)
    v_readfirstlane_b32 s52, v154
    s_cmp_lt_i32 s52, s35
    s_cbranch_scc1 L_poll78
L_ok77:
L_pml:
    buffer_load_dwordx4 v[108:111], v158, s[36:39], s53 offen offset:0 sc1
    buffer_load_dwordx4 v[112:115], v158, s[36:39], s53 offen offset:256 sc1
    s_sub_u32 s33, s33, 1
    s_cbranch_scc1 L_end
L_chk79:
    s_waitcnt vmcnt(1)
    v_xor_b32 v109, s44, v109
    v_xor_b32 v111, s44, v111
    v_or_b32 v152, v109, v111
    s_waitcnt vmcnt(0)
    v_xor_b32 v113, s44, v113
    v_xor_b32 v115, s44, v115
    v_or3_b32 v152, v152, v113, v115
    v_cmp_ne_u32 vcc, 0, v152
    s_mov_b64 exec, vcc
    s_cbranch_execnz L_pml
    s_mov_b64 exec, -1
    buffer_load_dwordx4 v[100:103], v159, s[36:39], s54 offen offset:0 sc1
    buffer_load_dwordx4 v[104:107], v159, s[36:39], s54 offen offset:1024 sc1
L_mlok:
    v_max_f32 v161, v108, v112
    s_nop 1
    v_max_f32_dpp v161, v161, v161 row_ror:4 row_mask:0xf bank_mask:0xf
    s_nop 1
    v_max_f32_dpp v161, v161, v161 row_ror:8 row_mask:0xf bank_mask:0xf
    v_mov_b32 v154, v161
    s_nop 1
    v_permlane16_swap_b32 v161, v154
    v_max_f32 v161, v161, v154
    v_mov_b32 v154, v161
    s_nop 1
    v_permlane32_swap_b32 v161, v154
    v_max_f32 v161, v161, v154
    v_sub_f32 v108, v108, v161
    v_sub_f32 v112, v112, v161
    v_exp_f32 v108, v108
    v_exp_f32 v112, v112
    v_mul_f32 v161, v108, v110
    v_fmac_f32 v161, v112, v114
    s_nop 1
    v_add_f32_dpp v161, v161, v161 row_ror:4 row_mask:0xf bank_mask:0xf
    s_nop 1
    v_add_f32_dpp v161, v161, v161 row_ror:8 row_mask:0xf bank_mask:0xf
    v_mov_b32 v154, v161
    s_nop 1
    v_permlane16_swap_b32 v161, v154
    v_add_f32 v161, v161, v154
    v_mov_b32 v154, v161
    s_nop 1
    v_permlane32_swap_b32 v161, v154
    v_add_f32 v161, v161, v154
    v_rcp_f32 v161, v161
    s_nop 0
    v_mul_f32 v108, v108, v161
    v_mul_f32 v112, v112, v161
    s_add_u32 s35, s46, 2
    s_cmp_ge_i32 s52, s35
    s_cbranch_scc1 L_ok81
L_poll82:
    ds_read_b32 v154, v153
    s_sub_u32 s33, s33, 1
    s_cbranch_scc1 L_end
    s_waitcnt lgkmcnt(0)
    v_readfirstlane_b32 s52, v154
    s_cmp_lt_i32 s52, s35
    s_cbranch_scc1 L_poll82
L_ok81:
    ds_read_b128 v[4:7], v157 offset:0
    ds_read_b128 v[8:11], v157 offset:256
    ds_read_b128 v[12:15], v157 offset:512
    ds_read_b128 v[16:19], v157 offset:768
    ds_read_b128 v[20:23], v157 offset:4096
    ds_read_b128 v[24:27], v157 offset:4352
    ds_read_b128 v[28:31], v157 offset:4608
    ds_read_b128 v[32:35], v157 offset:4864
    ds_read_b128 v[36:39], v157 offset:8192
    ds_read_b128 v[40:43], v157 offset:8448
    ds_read_b128 v[44:47], v157 offset:8704
    ds_read_b128 v[48:51], v157 offset:8960
    ds_read_b128 v[52:55], v157 offset:12288
    ds_read_b128 v[56:59], v157 offset:12544
    ds_read_b128 v[60:63], v157 offset:12800
    ds_read_b128 v[64:67], v157 offset:13056
    s_branch L_chk83
L_po:
    buffer_load_dwordx4 v[100:103], v159, s[36:39], s54 offen offset:0 sc1
    buffer_load_dwordx4 v[104:107], v159, s[36:39], s54 offen offset:1024 sc1
    s_sub_u32 s33, s33, 1
    s_cbranch_scc1 L_end
L_chk83:
    s_waitcnt vmcnt(1)
    v_xor_b32 v100, v100, v116
    v_xor_b32 v101, v101, v117
    v_xor_b32 v102, v102, v118
    v_xor_b32 v103, v103, v119
    v_or_b32 v152, v100, v101
    v_or3_b32 v152, v152, v102, v103
    s_waitcnt vmcnt(0)
    v_xor_b32 v104, v104, v116
    v_xor_b32 v105, v105, v117
    v_xor_b32 v106, v106, v118
    v_xor_b32 v107, v107, v119
    v_or3_b32 v152, v152, v104, v105
    v_or3_b32 v152, v152, v106, v107
    v_and_b32 v152, 1023, v152
    v_cmp_ne_u32 vcc, 0, v152
    s_mov_b64 exec, vcc
    s_cbranch_execnz L_po
    s_mov_b64 exec, -1
    s_cmp_ge_u32 s47, 64
    s_cbranch_scc1 L_noea
    s_not_b64 exec, s[50:51]
    buffer_load_dwordx4 v[120:123], v159, s[36:39], s55 offen offset:0 sc1
    buffer_load_dwordx4 v[124:127], v159, s[36:39], s55 offen offset:1024 sc1
    buffer_load_dwordx4 v[128:131], v159, s[36:39], s55 offen offset:2048 sc1
    buffer_load_dwordx4 v[132:135], v159, s[36:39], s55 offen offset:3072 sc1
    buffer_load_dwordx4 v[136:139], v159, s[36:39], s56 offen offset:0 sc1
    buffer_load_dwordx4 v[140:143], v159, s[36:39], s56 offen offset:1024 sc1
    buffer_load_dwordx4 v[144:147], v159, s[36:39], s56 offen offset:2048 sc1
    buffer_load_dwordx4 v[148:151], v159, s[36:39], s56 offen offset:3072 sc1
    s_mov_b64 exec, -1
L_noea:
    v_mul_f32 v100, v100, v108
    v_mul_f32 v101, v101, v108
    v_mul_f32 v102, v102, v108
    v_mul_f32 v103, v103, v108
    v_fmac_f32 v100, v104, v112
    v_fmac_f32 v101, v105, v112
    v_fmac_f32 v102, v106, v112
    v_fmac_f32 v103, v107, v112
    s_nop 0
    v_permlane32_swap_b32 v100, v102
    v_permlane32_swap_b32 v101, v103
    v_add_f32 v100, v100, v102
    v_add_f32 v101, v101, v103
    s_nop 1
    v_permlane16_swap_b32 v100, v101
    v_add_f32 v100, v100, v101
    s_nop 1
    v_add_f32_dpp v100, v100, v100 row_ror:4 row_mask:0xf bank_mask:0xf
    s_nop 1
    v_add_f32_dpp v100, v100, v100 row_ror:8 row_mask:0xf bank_mask:0xf
    v_cvt_pk_bf16_f32 v100, v100, v100
    s_waitcnt lgkmcnt(0)
    s_nop 0
    v_and_b32_dpp v68, v100, v166 quad_perm:[0,0,0,0] row_mask:0xf bank_mask:0xf
    v_and_b32_dpp v69, v100, v167 quad_perm:[0,0,0,0] row_mask:0xf bank_mask:0xf
    v_and_b32_dpp v70, v100, v168 quad_perm:[0,0,0,0] row_mask:0xf bank_mask:0xf
    v_and_b32_dpp v71, v100, v169 quad_perm:[0,0,0,0] row_mask:0xf bank_mask:0xf
    v_and_b32_dpp v72, v100, v166 quad_perm:[1,1,1,1] row_mask:0xf bank_mask:0xf
    v_and_b32_dpp v73, v100, v167 quad_perm:[1,1,1,1] row_mask:0xf bank_mask:0xf
    v_and_b32_dpp v74, v100, v168 quad_perm:[1,1,1,1] row_mask:0xf bank_mask:0xf
    v_and_b32_dpp v75, v100, v169 quad_perm:[1,1,1,1] row_mask:0xf bank_mask:0xf
    v_and_b32_dpp v76, v100, v166 quad_perm:[2,2,2,2] row_mask:0xf bank_mask:0xf
    v_and_b32_dpp v77, v100, v167 quad_perm:[2,2,2,2] row_mask:0xf bank_mask:0xf
    v_and_b32_dpp v78, v100, v168 quad_perm:[2,2,2,2] row_mask:0xf bank_mask:0xf
    v_and_b32_dpp v79, v100, v169 quad_perm:[2,2,2,2] row_mask:0xf bank_mask:0xf
    v_and_b32_dpp v80, v100, v166 quad_perm:[3,3,3,3] row_mask:0xf bank_mask:0xf
    v_and_b32_dpp v81, v100, v167 quad_perm:[3,3,3,3] row_mask:0xf bank_mask:0xf
    v_and_b32_dpp v82, v100, v168 quad_perm:[3,3,3,3] row_mask:0xf bank_mask:0xf
    v_and_b32_dpp v83, v100, v169 quad_perm:[3,3,3,3] row_mask:0xf bank_mask:0xf
    v_mfma_f32_16x16x32_bf16 v[84:87], v[68:71], v[4:7], 0
    v_mfma_f32_16x16x32_bf16 v[84:87], v[72:75], v[20:23], v[84:87]
    v_mfma_f32_16x16x32_bf16 v[84:87], v[76:79], v[36:39], v[84:87]
    v_mfma_f32_16x16x32_bf16 v[84:87], v[80:83], v[52:55], v[84:87]
    v_mfma_f32_16x16x32_bf16 v[88:91], v[68:71], v[8:11], 0
    v_mfma_f32_16x16x32_bf16 v[88:91], v[72:75], v[24:27], v[88:91]
    v_mfma_f32_16x16x32_bf16 v[88:91], v[76:79], v[40:43], v[88:91]
    v_mfma_f32_16x16x32_bf16 v[88:91], v[80:83], v[56:59], v[88:91]
    v_mfma_f32_16x16x32_bf16 v[92:95], v[68:71], v[12:15], 0
    v_mfma_f32_16x16x32_bf16 v[92:95], v[72:75], v[28:31], v[92:95]
    v_mfma_f32_16x16x32_bf16 v[92:95], v[76:79], v[44:47], v[92:95]
    v_mfma_f32_16x16x32_bf16 v[92:95], v[80:83], v[60:63], v[92:95]
    v_and_or_b32 v84, v84, s45, v116
    v_and_or_b32 v85, v85, s45, v117
    v_and_or_b32 v86, v86, s45, v118
    v_and_or_b32 v87, v87, s45, v119
    s_mov_b32 exec_hi, 0
    buffer_store_dwordx4 v[84:87], v160, s[36:39], 0 offen sc1
    s_mov_b32 exec_hi, -1
    v_mfma_f32_16x16x32_bf16 v[96:99], v[68:71], v[16:19], 0
    v_mfma_f32_16x16x32_bf16 v[96:99], v[72:75], v[32:35], v[96:99]
    v_mfma_f32_16x16x32_bf16 v[96:99], v[76:79], v[48:51], v[96:99]
    v_mfma_f32_16x16x32_bf16 v[96:99], v[80:83], v[64:67], v[96:99]
    v_and_or_b32 v88, v88, s45, v116
    v_and_or_b32 v89, v89, s45, v117
    v_and_or_b32 v90, v90, s45, v118
    v_and_or_b32 v91, v91, s45, v119
    s_mov_b32 exec_hi, 0
    buffer_store_dwordx4 v[88:91], v160, s[36:39], s60 offen sc1
    s_mov_b32 exec_hi, -1
    v_and_or_b32 v92, v92, s45, v116
    v_and_or_b32 v93, v93, s45, v117
    v_and_or_b32 v94, v94, s45, v118
    v_and_or_b32 v95, v95, s45, v119
    s_mov_b32 exec_hi, 0
    buffer_store_dwordx4 v[92:95], v160, s[36:39], s61 offen sc1
    s_mov_b32 exec_hi, -1
    v_and_or_b32 v96, v96, s45, v116
    v_and_or_b32 v97, v97, s45, v117
    v_and_or_b32 v98, v98, s45, v118
    v_and_or_b32 v99, v99, s45, v119
    s_mov_b32 exec_hi, 0
    buffer_store_dwordx4 v[96:99], v160, s[36:39], s62 offen sc1
    s_mov_b32 exec_hi, -1
    s_cmp_ge_u32 s47, 64
    s_cbranch_scc1 L_end
    s_waitcnt vmcnt(0)
    s_not_b64 exec, s[50:51]
    s_branch L_chk85
L_ga:
    buffer_load_dwordx4 v[120:123], v159, s[36:39], s55 offen offset:0 sc1
    buffer_load_dwordx4 v[124:127], v159, s[36:39], s55 offen offset:1024 sc1
    buffer_load_dwordx4 v[128:131], v159, s[36:39], s55 offen offset:2048 sc1
    buffer_load_dwordx4 v[132:135], v159, s[36:39], s55 offen offset:3072 sc1
    buffer_load_dwordx4 v[136:139], v159, s[36:39], s56 offen offset:0 sc1
    buffer_load_dwordx4 v[140:143], v159, s[36:39], s56 offen offset:1024 sc1
    buffer_load_dwordx4 v[144:147], v159, s[36:39], s56 offen offset:2048 sc1
    buffer_load_dwordx4 v[148:151], v159, s[36:39], s56 offen offset:3072 sc1
    s_sub_u32 s33, s33, 1
    s_cbranch_scc1 L_end
L_chk85:
    s_waitcnt vmcnt(7)
    v_xor_b32 v120, v120, v116
    v_xor_b32 v121, v121, v117
    v_xor_b32 v122, v122, v118
    v_xor_b32 v123, v123, v119
    v_or_b32 v152, v120, v121
    v_or3_b32 v152, v152, v122, v123
    s_waitcnt vmcnt(6)
    v_xor_b32 v124, v124, v116
    v_xor_b32 v125, v125, v117
    v_xor_b32 v126, v126, v118
    v_xor_b32 v127, v127, v119
    v_or3_b32 v152, v152, v124, v125
    v_or3_b32 v152, v152, v126, v127
    s_waitcnt vmcnt(5)
    v_xor_b32 v128, v128, v116
    v_xor_b32 v129, v129, v117
    v_xor_b32 v130, v130, v118
    v_xor_b32 v131, v131, v119
    v_or3_b32 v152, v152, v128, v129
    v_or3_b32 v152, v152, v130, v131
    s_waitcnt vmcnt(4)
    v_xor_b32 v132, v132, v116
    v_xor_b32 v133, v133, v117
    v_xor_b32 v134, v134, v118
    v_xor_b32 v135, v135, v119
    v_or3_b32 v152, v152, v132, v133
    v_or3_b32 v152, v152, v134, v135
    s_waitcnt vmcnt(3)
    v_xor_b32 v136, v136, v116
    v_xor_b32 v137, v137, v117
    v_xor_b32 v138, v138, v118
    v_xor_b32 v139, v139, v119
    v_or3_b32 v152, v152, v136, v137
    v_or3_b32 v152, v152, v138, v139
    s_waitcnt vmcnt(2)
    v_xor_b32 v140, v140, v116
    v_xor_b32 v141, v141, v117
    v_xor_b32 v142, v142, v118
    v_xor_b32 v143, v143, v119
    v_or3_b32 v152, v152, v140, v141
    v_or3_b32 v152, v152, v142, v143
    s_waitcnt vmcnt(1)
    v_xor_b32 v144, v144, v116
    v_xor_b32 v145, v145, v117
    v_xor_b32 v146, v146, v118
    v_xor_b32 v147, v147, v119
    v_or3_b32 v152, v152, v144, v145
    v_or3_b32 v152, v152, v146, v147
    s_waitcnt vmcnt(0)
    v_xor_b32 v148, v148, v116
    v_xor_b32 v149, v149, v117
    v_xor_b32 v150, v150, v118
    v_xor_b32 v151, v151, v119
    v_or3_b32 v152, v152, v148, v149
    v_or3_b32 v152, v152, v150, v151
    v_and_b32 v152, 1023, v152
    v_cmp_ne_u32 vcc, 0, v152
    s_or_b64 exec, vcc, s[50:51]
    s_mov_b64 s[50:51], 0
    s_cbranch_execnz L_ga
    s_mov_b64 exec, -1
    v_pk_add_f32 v[120:121], v[120:121], v[136:137]
    v_pk_add_f32 v[122:123], v[122:123], v[138:139]
    v_pk_add_f32 v[124:125], v[124:125], v[140:141]
    v_pk_add_f32 v[126:127], v[126:127], v[142:143]
    v_pk_add_f32 v[128:129], v[128:129], v[144:145]
    v_pk_add_f32 v[130:131], v[130:131], v[146:147]
    v_pk_add_f32 v[132:133], v[132:133], v[148:149]
    v_pk_add_f32 v[134:135], v[134:135], v[150:151]
    v_pk_add_f32 v[120:121], v[120:121], v[128:129]
    v_pk_add_f32 v[122:123], v[122:123], v[130:131]
    v_pk_add_f32 v[124:125], v[124:125], v[132:133]
    v_pk_add_f32 v[126:127], v[126:127], v[134:135]
    v_pk_add_f32 v[120:121], v[120:121], v[124:125]
    v_pk_add_f32 v[122:123], v[122:123], v[126:127]
    s_nop 1
    v_permlane32_swap_b32 v120, v122
    v_permlane32_swap_b32 v121, v123
    v_add_f32 v120, v120, v122
    v_add_f32 v121, v121, v123
    s_nop 1
    v_permlane16_swap_b32 v120, v121
    v_add_f32 v120, v120, v121
    s_nop 1
    v_add_f32_dpp v120, v120, v120 row_ror:2 row_mask:0xf bank_mask:0xf
    s_nop 1
    v_add_f32_dpp v120, v120, v120 row_ror:4 row_mask:0xf bank_mask:0xf
    s_nop 1
    v_add_f32_dpp v120, v120, v120 row_ror:8 row_mask:0xf bank_mask:0xf
    v_cvt_pk_bf16_f32 v120, v120, v120
    v_lshlrev_b32 v120, 16, v120
    v_add_f32 v164, v164, v120
    v_cvt_pk_bf16_f32 v164, v164, v164
    v_lshlrev_b32 v164, 16, v164
    v_add_f32 v164, v164, v165
    v_cvt_pk_bf16_f32 v164, v164, v164
    s_mov_b32 exec_lo, 0x30003
    s_mov_b32 exec_hi, 0x30003
    global_store_short v163, v164, s[24:25]
    s_cmp_lg_u32 s47, 0
    s_cbranch_scc1 L_noep
    s_mov_b64 exec, 1
    v_mov_b32 v154, s44
    v_mov_b32 v156, 32768
    buffer_store_dword v154, v156, s[36:39], 0 offen sc1
L_noep:
L_end:
    s_endpgm
.section .rodata,"a"
.p2align 6
.amdhsa_kernel parallel_sum__gqa_block_cached__dense_activation_gelu__decode_kernel
  .amdhsa_next_free_vgpr 360
  .amdhsa_next_free_sgpr 102
  .amdhsa_accum_offset 232
  .amdhsa_group_segment_fixed_size 0
  .amdhsa_kernarg_size 104
  .amdhsa_user_sgpr_count 2
  .amdhsa_user_sgpr_kernarg_segment_ptr 1
  .amdhsa_system_sgpr_workgroup_id_x 1
.end_amdhsa_kernel
```
